```python
import torch

def _softmax(x, axis=-1):
    return torch.softmax(x, dim=axis)

def _gelu(x):
    return torch.nn.functional.gelu(x, approximate='tanh')

def _silu(x):
    return torch.nn.functional.silu(x)

def _sigmoid(x):
    return torch.sigmoid(x)

def _layernorm(x, axis=-1, eps=1e-05):
    m = x.mean(dim=axis, keepdim=True)
    v = x.var(dim=axis, keepdim=True, unbiased=False)
    return (x - m) / torch.sqrt(v + eps)

def _scatter_add(tgt, idx, src, axis=0):
    return tgt.clone().index_add_(axis, idx, src)

def _segment_sum(src, seg, n):
    out = torch.zeros((n,) + src.shape[1:], dtype=src.dtype)
    return out.index_add_(0, seg, src)

def _pad(x, pw):
    flat = tuple((v for pair in reversed(pw) for v in pair))
    return torch.nn.functional.pad(x, flat)
kernel_name = 'adaLN_cond__ssm_conv_s4d__mixer_gmlp__prompt'

def setup_inputs():

    _w = lambda a: (lambda t: t.to(torch.bfloat16) if t.is_floating_point() else t)(torch.as_tensor(a))

    def _A_setup():
        Bsz, L, D, N = (1, 2048, 512, 128)
        return {'u': _w((lambda *s: torch.randn(*s, dtype=torch.bfloat16) * 0.05)(Bsz, L, D)), 'log_A_real': _w((lambda *s: torch.randn(*s, dtype=torch.bfloat16) * 3.2)(D, N) * 0.5), 'A_imag': _w((lambda *s: torch.randn(*s, dtype=torch.bfloat16) * 0.2)(D, N) * 3.14), 'C_real': _w((lambda *s: torch.randn(*s, dtype=torch.bfloat16) * 0.8)(D, N) / N ** 0.5), 'C_imag': _w((lambda *s: torch.randn(*s, dtype=torch.bfloat16) * 0.8)(D, N) / N ** 0.5), 'log_dt': _w((lambda *s: torch.randn(*s, dtype=torch.bfloat16) * 0.2)(D) * 0.5 - 4.0), 'D_skip': _w((lambda *s: torch.randn(*s, dtype=torch.bfloat16) * 0.2)(D))}
    _A_in = _A_setup()

    def _B_setup():
        B, S, D, F = (1, 2048, 512, 1376)
        Fh = F // 2
        return {'x': _w((lambda *s: torch.randn(*s, dtype=torch.bfloat16) * 0.05)(B, S, D)), 'w_in': _w((lambda *s: torch.randn(*s, dtype=torch.bfloat16) * 0.4)(D, 2 * Fh)), 'w_sp': _w(0.01 * (lambda *s: torch.randn(*s, dtype=torch.bfloat16) * 0.4)(S, S)), 'b_sp': _w(1.0 + 0.01 * (lambda *s: torch.randn(*s, dtype=torch.bfloat16) * 0.05)(S)), 'w_out': _w((lambda *s: torch.randn(*s, dtype=torch.bfloat16) * 0.05)(Fh, D))}
    _B_in = _B_setup()
    return {'A_u': _A_in['u'], 'A_log_A_real': _A_in['log_A_real'], 'A_A_imag': _A_in['A_imag'], 'A_C_real': _A_in['C_real'], 'A_C_imag': _A_in['C_imag'], 'A_log_dt': _A_in['log_dt'], 'A_D_skip': _A_in['D_skip'], 'B_x': _B_in['x'], 'B_w_in': _B_in['w_in'], 'B_w_sp': _B_in['w_sp'], 'B_b_sp': _B_in['b_sp'], 'B_w_out': _B_in['w_out'], 'c': _w((lambda *s: torch.randn(*s, dtype=torch.bfloat16) * 0.2)(1, 512) * 8.0), 'w_mod': _w((lambda *s: torch.randn(*s, dtype=torch.bfloat16) * 0.2)(512, 6 * 512) * 512 ** (-0.5) * 8.0)}

def reference(A_u, A_log_A_real, A_A_imag, A_C_real, A_C_imag, A_log_dt, A_D_skip, B_x, B_w_in, B_w_sp, B_b_sp, B_w_out, c, w_mod):

    def _A_ref(u, log_A_real, A_imag, C_real, C_imag, log_dt, D_skip):
        L = u.shape[1]
        dt = torch.exp(log_dt)
        A = -torch.exp(log_A_real) + 1j * A_imag
        C = (C_real + 1j * C_imag) * dt[:, None]
        pos = (lambda x, dt: x.to(dt))(torch.arange(L), log_dt.dtype)
        P = torch.exp((A * dt[:, None])[:, :, None] * pos[None, None, :])
        K = 2.0 * torch.einsum('dn,dnl->dl', C, P).real
        L2 = 2 * L
        u_t = (lambda x, *d: x.permute(*d))(u, 0, 2, 1)
        Kf = (lambda x, *a, **k: torch.fft.rfft(x.float(), *a, **k))(K, L2)
        Uf = (lambda x, *a, **k: torch.fft.rfft(x.float(), *a, **k))(u_t, L2)
        y = (lambda x, *a, **k: torch.fft.irfft(x, *a, **k).to(torch.bfloat16))(Uf * Kf[None, :, :], L2)[:, :, :L]
        y = (lambda x, *d: x.permute(*d))(y, 0, 2, 1)
        return y + u * D_skip[None, None, :]

    def _B_ref(x, w_in, w_sp, b_sp, w_out):
        B, S, D = x.shape
        F = w_in.shape[-1]
        Fh = F // 2
        z = _gelu(torch.einsum('bsd,df->bsf', x, w_in))
        z1 = z[..., :Fh].clone()
        z2 = _layernorm(z[..., Fh:], axis=-1)
        g = torch.einsum('ts,bsf->btf', w_sp, z2) + b_sp[None, :, None]
        return torch.einsum('bsf,fd->bsd', z1 * g, w_out)
    x = A_u
    mod = (_silu(c) @ w_mod).reshape(c.shape[0], 6, 1, -1)
    sa, ca, ga, sb, cb, gb = (mod[:, 0].clone(), mod[:, 1].clone(), mod[:, 2].clone(), mod[:, 3].clone(), mod[:, 4].clone(), mod[:, 5].clone())
    h = _layernorm(x, axis=-1) * (1 + ca) + sa
    x = x + ga * _A_ref(h, A_log_A_real, A_A_imag, A_C_real, A_C_imag, A_log_dt, A_D_skip)
    h = _layernorm(x, axis=-1) * (1 + cb) + sb
    x = x + gb * _B_ref(h, B_w_in, B_w_sp, B_b_sp, B_w_out)
    return x
```

```asm
; @launch grid=(256,1,1) block=(512,1,1) lds=155904
.amdgcn_target "amdgcn-amd-amdhsa--gfx950"
.text
.globl adaLN_cond__ssm_conv_s4d__mixer_gmlp__prompt_kernel
.p2align 8
.type adaLN_cond__ssm_conv_s4d__mixer_gmlp__prompt_kernel,@function
adaLN_cond__ssm_conv_s4d__mixer_gmlp__prompt_kernel:
    s_cmp_ge_u32 s2, 256
    s_cbranch_scc1 kab_oob
    s_mov_b32 s97, 0xffff0000
    s_load_dwordx16 s[64:79], s[0:1], 0
    s_load_dwordx8 s[80:87], s[0:1], 64
    s_load_dwordx4 s[92:95], s[0:1], 96
    s_load_dwordx4 s[32:35], s[0:1], 120
    s_getpc_b64 s[12:13]
adaLN_cond__ssm_conv_s4d__mixer_gmlp__prompt_kernel_pc:
    s_lshr_b32 s14, s2, 3
    s_mul_i32 s14, s14, 8192
    v_lshl_add_u32 v240, v0, 4, s14
    s_mov_b32 s15, all_code_end-adaLN_cond__ssm_conv_s4d__mixer_gmlp__prompt_kernel_pc-16
    v_cmp_gt_u32 vcc, s15, v240
    v_min_u32 v240, s15, v240
    s_nop 3
    s_cbranch_vccz adaLN_cond__ssm_conv_s4d__mixer_gmlp__prompt_kernel_npf
    v_and_b32 v240, -4, v240
    v_mov_b32 v241, s13
    v_add_co_u32 v240, vcc, s12, v240
    s_nop 1
    v_addc_co_u32 v241, vcc, 0, v241, vcc
    global_load_dwordx4 v[242:245], v[240:241], off
adaLN_cond__ssm_conv_s4d__mixer_gmlp__prompt_kernel_npf:
    v_and_b32 v1, 63, v0
    v_lshrrev_b32 v2, 6, v0
    s_nop 0
    v_readfirstlane_b32 s11, v2
    s_and_b32 s4, s2, 7
    s_lshl_b32 s4, s4, 5
    s_lshr_b32 s5, s2, 3
    s_add_u32 s4, s4, s5
    s_and_b32 s3, s11, 3
    s_lshr_b32 s88, s4, 1
    s_lshl_b32 s88, s88, 2
    s_and_b32 s89, s4, 1
    s_add_u32 s88, s88, s89
    v_lshlrev_b32 v3, 4, v1
    v_mov_b32 v248, 1
    s_cmp_ge_u32 s11, 4
    s_cbranch_scc1 kab_h
    v_and_b32 v4, 31, v0
    v_bfe_u32 v5, v0, 5, 1
    v_lshl_add_u32 v4, v2, 5, v4
    v_lshlrev_b32_e64 v4, 1, v4
    v_lshl_add_u32 v4, v5, 9, v4
    s_lshl_b32 s54, s88, 8
    s_lshl_b32 s55, s88, 1
    v_lshlrev_b32 v29, 2, v5
    v_mov_b32 v110, 0
    s_waitcnt lgkmcnt(0)
    s_mov_b64 s[36:37], s[34:35]
    s_mov_b32 s12, s74
    s_and_b32 s13, s75, 0xffff
    s_mov_b32 s14, 1024
    s_mov_b32 s15, 0x00020000
    buffer_load_ushort v10, v29, s[12:15], s55 offen
    s_mov_b32 s16, s66
    s_and_b32 s17, s67, 0xffff
    s_mov_b32 s18, 131072
    s_mov_b32 s19, 0x00020000
    buffer_load_ushort v11, v4, s[16:19], s54 offen nt
    s_mov_b32 s20, s68
    s_and_b32 s21, s69, 0xffff
    s_mov_b32 s22, 131072
    s_mov_b32 s23, 0x00020000
    buffer_load_ushort v12, v4, s[20:23], s54 offen nt
    s_mov_b32 s24, s70
    s_and_b32 s25, s71, 0xffff
    s_mov_b32 s26, 131072
    s_mov_b32 s27, 0x00020000
    buffer_load_ushort v13, v4, s[24:27], s54 offen nt
    s_mov_b32 s28, s72
    s_and_b32 s29, s73, 0xffff
    s_mov_b32 s30, 131072
    s_mov_b32 s31, 0x00020000
    buffer_load_ushort v14, v4, s[28:31], s54 offen nt
    s_mov_b32 s12, s76
    s_and_b32 s13, s77, 0xffff
    s_mov_b32 s14, 1024
    s_mov_b32 s15, 0x00020000
    buffer_load_ushort v111, v29, s[12:15], s55 offen
    s_barrier
    v_and_b32 v6, 15, v1
    v_lshrrev_b32 v7, 4, v1
    v_lshrrev_b32 v8, 3, v6
    v_and_b32_e64 v9, 7, v6
    v_lshl_add_u32 v8, v8, 7, v9
    v_add_u32 v8, 1, v8
    v_cvt_f32_u32 v20, v8
    v_lshrrev_b32 v8, 2, v6
    v_and_b32 v15, 3, v6
    v_lshlrev_b32_e64 v15, 1, v15
    v_lshl_add_u32 v8, v8, 7, v15
    v_add_u32 v8, 258, v8
    v_lshrrev_b32 v15, 1, v9
    v_and_b32 v16, 1, v6
    v_lshlrev_b32_e64 v16, 2, v16
    v_lshl_add_u32 v15, v15, 7, v16
    v_add_u32 v15, 516, v15
    v_cmp_gt_u32 vcc, 8, v6
    s_nop 1
    v_cndmask_b32 v8, v15, v8, vcc
    v_cvt_f32_u32 v42, v8
    v_lshlrev_b32 v8, 3, v6
    v_cvt_f32_u32 v22, v8
    v_mul_u32_u24 v24, 3136, v2
    v_add_u32 v24, 50560, v24
    v_lshrrev_b32 v8, 1, v7
    v_and_b32 v9, 1, v7
    v_lshlrev_b32_e64 v15, 7, v8
    v_lshl_add_u32 v15, v9, 2, v15
    v_lshl_add_u32 v15, v6, 3, v15
    v_add_u32_e64 v15, 4, v15
    v_lshl_add_u32 v25, v15, 2, v24
    v_lshl_add_u32 v15, v8, 4, v6
    v_add_u32 v15, 516, v15
    v_add_u32 v16, 660, v6
    v_cmp_eq_u32 vcc, 1, v9
    s_nop 1
    v_cndmask_b32 v15, v16, v15, vcc
    v_lshl_add_u32 v28, v15, 2, v24
    v_lshlrev_b32 v8, 6, v7
    v_add_u32 v8, 260, v8
    v_lshl_add_u32 v9, v6, 2, v8
    v_lshl_add_u32 v15, v6, 1, v8
    v_cmp_gt_u32 vcc, 2, v7
    s_nop 1
    v_cndmask_b32 v8, v15, v9, vcc
    v_lshl_add_u32 v26, v8, 2, v24
    v_mov_b32 v9, 128
    v_cndmask_b32 v9, v9, 8, vcc
    v_add_u32 v27, v26, v9
    v_add_u32_e64 v8, 2, v7
    v_lshl_add_u32 v9, v7, 1, 1
    v_cndmask_b32 v8, v9, v8, vcc
    v_lshl_add_u32 v8, v8, 4, v6
    v_add_u32 v8, 516, v8
    v_lshl_add_u32 v17, v8, 2, v24
    v_lshl_add_u32 v8, v7, 5, v6
    v_add_u32 v8, 516, v8
    v_cndmask_b32 v8, v8, v16, vcc
    v_lshl_add_u32 v18, v8, 2, v24
    v_mul_u32_u24 v19, 12544, v5
    v_add3_u32 v19, v19, v24, 12
    v_lshlrev_b32_e64 v8, 3, v0
    v_sub_u32 v8, 2047, v8
    s_movk_i32 s44, 0x80
    s_mov_b32 s45, 17024
    v_cvt_f32_u32 v9, v8
    v_cvt_pk_bf16_f32 v9, v9, v9
    v_lshrrev_b32 v9, 16, v9
    v_subrev_u32 v9, s45, v9
    v_med3_i32 v9, v9, v8, s44
    v_lshlrev_b32 v30, 1, v9
    v_subrev_u32 v8, 1, v8
    v_cvt_f32_u32_e64 v9, v8
    v_cvt_pk_bf16_f32 v9, v9, v9
    v_lshrrev_b32 v9, 16, v9
    v_subrev_u32 v9, s45, v9
    v_med3_i32 v9, v9, v8, s44
    v_lshlrev_b32 v31, 1, v9
    v_subrev_u32 v8, 1, v8
    v_cvt_f32_u32_e64 v9, v8
    v_cvt_pk_bf16_f32 v9, v9, v9
    v_lshrrev_b32 v9, 16, v9
    v_subrev_u32 v9, s45, v9
    v_med3_i32 v9, v9, v8, s44
    v_lshlrev_b32 v32, 1, v9
    v_subrev_u32 v8, 1, v8
    v_cvt_f32_u32_e64 v9, v8
    v_cvt_pk_bf16_f32 v9, v9, v9
    v_lshrrev_b32 v9, 16, v9
    v_subrev_u32 v9, s45, v9
    v_med3_i32 v9, v9, v8, s44
    v_lshlrev_b32 v33, 1, v9
    v_subrev_u32 v8, 1, v8
    v_cvt_f32_u32_e64 v9, v8
    v_cvt_pk_bf16_f32 v9, v9, v9
    v_lshrrev_b32 v9, 16, v9
    v_subrev_u32 v9, s45, v9
    v_med3_i32 v9, v9, v8, s44
    v_lshlrev_b32 v34, 1, v9
    v_subrev_u32 v8, 1, v8
    v_cvt_f32_u32_e64 v9, v8
    v_cvt_pk_bf16_f32 v9, v9, v9
    v_lshrrev_b32 v9, 16, v9
    v_subrev_u32 v9, s45, v9
    v_med3_i32 v9, v9, v8, s44
    v_lshlrev_b32 v35, 1, v9
    v_subrev_u32 v8, 1, v8
    v_cvt_f32_u32_e64 v9, v8
    v_cvt_pk_bf16_f32 v9, v9, v9
    v_lshrrev_b32 v9, 16, v9
    v_subrev_u32 v9, s45, v9
    v_med3_i32 v9, v9, v8, s44
    v_lshlrev_b32 v36, 1, v9
    v_subrev_u32 v8, 1, v8
    v_cvt_f32_u32_e64 v9, v8
    v_cvt_pk_bf16_f32 v9, v9, v9
    v_lshrrev_b32 v9, 16, v9
    v_subrev_u32 v9, s45, v9
    v_med3_i32 v9, v9, v8, s44
    v_lshlrev_b32 v37, 1, v9
    v_subrev_u32 v8, 1, v8
    v_max_i32 v8, 0, v8
    v_cvt_f32_u32 v9, v8
    v_cvt_pk_bf16_f32 v9, v9, v9
    v_lshrrev_b32 v9, 16, v9
    v_subrev_u32 v9, s45, v9
    v_med3_i32 v9, v9, v8, s44
    v_lshlrev_b32_e64 v38, 1, v9
    s_mov_b32 s46, 0x3fb8aa00
    s_mov_b32 s47, 0x36eca570
    s_mov_b32 s48, 0xbfb8aa3b
    s_mov_b32 s49, 0x3e22f983
    s_mov_b32 s58, 0x44800000
    v_mul_u32_u24 v8, 3072, v2
    v_add_u32 v8, 34176, v8
    v_mad_u32_u24 v40, v1, 48, v8
    v_mul_u32_u24 v41, 384, v7
    v_add_u32 v41, v41, v8
    s_waitcnt vmcnt(5)
    v_lshlrev_b32 v10, 16, v10
    v_mul_f32 v15, s46, v10
    v_mul_f32 v16, s47, v10
    v_exp_f32 v15, v15
    v_exp_f32 v16, v16
    s_nop 0
    v_mul_f32 v10, v15, v16
    v_cvt_pk_bf16_f32 v10, v10, v10
    v_and_b32 v10, s97, v10
    s_waitcnt vmcnt(4)
    v_lshlrev_b32 v11, 16, v11
    v_mul_f32 v15, s46, v11
    v_mul_f32 v16, s47, v11
    v_exp_f32 v15, v15
    v_exp_f32 v16, v16
    s_nop 0
    v_mul_f32_e64 v11, v15, v16
    v_cvt_pk_bf16_f32 v11, v11, v11
    v_and_b32 v11, s97, v11
    v_mul_f32 v11, v11, v10
    v_mul_f32 v44, s48, v11
    s_waitcnt vmcnt(3)
    v_lshlrev_b32 v12, 16, v12
    v_mul_f32 v12, v12, v10
    v_mul_f32_e64 v45, s49, v12
    v_pk_mul_f32 v[52:53], v[44:45], s[58:59] op_sel_hi:[1,0]
    v_fract_f32 v53, v53
    v_exp_f32 v52, v52
    v_cos_f32 v54, v53
    v_sin_f32 v55, v53
    s_nop 0
    v_pk_mul_f32 v[54:55], v[54:55], v[52:53] op_sel_hi:[1,0]
    s_waitcnt vmcnt(0)
    v_lshlrev_b32 v13, 16, v13
    v_lshlrev_b32 v14, 16, v14
    v_max_f32 v15, abs(v13), abs(v14)
    v_add_f32_dpp v16, v13, v13 row_ror:8 row_mask:0xf bank_mask:0xf
    s_nop 0
    v_max_f32_dpp v15, v15, v15 row_ror:8 row_mask:0xf bank_mask:0xf
    s_nop 1
    v_max_f32_dpp v15, v15, v15 row_ror:4 row_mask:0xf bank_mask:0xf
    v_add_f32_dpp v16, v16, v16 row_ror:4 row_mask:0xf bank_mask:0xf
    s_nop 0
    v_max_f32_dpp v15, v15, v15 row_ror:2 row_mask:0xf bank_mask:0xf
    v_add_f32_dpp v16, v16, v16 row_ror:2 row_mask:0xf bank_mask:0xf
    s_nop 0
    v_max_f32_dpp v15, v15, v15 row_ror:1 row_mask:0xf bank_mask:0xf
    v_add_f32_dpp v16, v16, v16 row_ror:1 row_mask:0xf bank_mask:0xf
    v_mov_b32 v8, v15
    v_mov_b32 v9, v16
    s_nop 0
    v_permlane16_swap_b32 v8, v15
    v_permlane16_swap_b32 v9, v16
    v_max_f32 v15, v15, v8
    v_add_f32_e64 v16, v16, v9
    v_and_b32 v15, 0x7f800000, v15
    v_max_u32 v15, 0x00800000, v15
    v_min_u32 v15, 0x7e800000, v15
    v_sub_u32 v8, 0x7f000000, v15
    v_mul_f32_e64 v46, v8, v13
    v_mul_f32 v47, -v8, v14
    v_add_f32 v10, v10, v10
    v_mul_f32 v16, v16, v10
    v_mul_f32 v15, v15, v10
    v_mov_b32 v48, v47
    v_sub_f32 v49, 0, v46
    v_mul_f32 v50, v54, v46
    v_fma_f32 v50, v55, v47, v50
    v_mul_f32_e64 v51, v54, v47
    v_fma_f32 v51, -v55, v46, v51
    v_mov_b32 v52, v51
    v_sub_f32 v53, 0, v50
    ds_write_b128 v40, v[44:47]
    ds_write_b128 v40, v[48:51] offset:16
    ds_write_b64 v40, v[52:53] offset:32
    s_mov_b32 exec_lo, 1
    s_mov_b32 exec_hi, 1
    ds_write_b32 v19, v16
    s_mov_b64 exec, -1
    v_readlane_b32 s50, v15, 0
    v_readlane_b32 s52, v15, 32
    s_mov_b32 s53, 0
    s_waitcnt lgkmcnt(0)
    s_nop 0
kab_kloop:
    ds_read_b128 v[128:131], v41 offset:0
    ds_read_b128 v[132:135], v41 offset:16
    ds_read_b64 v[136:137], v41 offset:32
    ds_read_b128 v[138:141], v41 offset:48
    ds_read_b128 v[142:145], v41 offset:64
    ds_read_b64 v[146:147], v41 offset:80
    ds_read_b128 v[148:151], v41 offset:96
    ds_read_b128 v[152:155], v41 offset:112
    ds_read_b64 v[156:157], v41 offset:128
    ds_read_b128 v[158:161], v41 offset:144
    ds_read_b128 v[162:165], v41 offset:160
    ds_read_b64 v[166:167], v41 offset:176
    s_bitcmp1_b32 s53, 0
    s_cbranch_scc1 kab_knz
    v_mov_b32 v48, 0
    v_mov_b32 v49, 0
    v_mov_b32 v50, 0
    v_mov_b32 v51, 0
    v_mov_b32 v52, 0
    v_mov_b32 v53, 0
    v_mov_b32 v54, 0
    v_mov_b32 v55, 0
    v_mov_b32 v56, 0
    v_mov_b32 v57, 0
    v_mov_b32 v58, 0
    v_mov_b32 v59, 0
    v_mov_b32 v60, 0
    v_mov_b32 v61, 0
    v_mov_b32 v62, 0
    v_mov_b32 v63, 0
kab_knz:
    s_waitcnt lgkmcnt(9)
    v_pk_mul_f32 v[104:105], v[128:129], v[20:21] op_sel_hi:[1,0]
    v_pk_mul_f32 v[106:107], v[128:129], v[42:43] op_sel_hi:[1,0]
    v_pk_mul_f32 v[108:109], v[128:129], v[22:23] op_sel_hi:[1,0]
    v_fract_f32 v105, v105
    v_exp_f32 v104, v104
    v_fract_f32 v107, v107
    v_exp_f32 v106, v106
    v_fract_f32 v109, v109
    v_exp_f32 v108, v108
    v_cos_f32 v120, v105
    v_sin_f32 v121, v105
    v_cos_f32 v122, v107
    v_sin_f32 v123, v107
    v_cos_f32 v124, v109
    v_sin_f32_e64 v126, v109
    v_pk_mul_f32 v[120:121], v[120:121], v[104:105] op_sel_hi:[1,0]
    v_pk_mul_f32 v[122:123], v[122:123], v[106:107] op_sel_hi:[1,0]
    v_mul_f32 v124, v124, v108
    v_mul_f32 v126, v126, v108
    v_cvt_pk_f16_f32 v88, v120, v121
    v_cvt_pk_f16_f32 v92, v122, v123
    v_pk_mul_f32 v[104:105], v[130:131], v[124:125] op_sel_hi:[1,0]
    v_pk_mul_f32 v[106:107], v[134:135], v[124:125] op_sel_hi:[1,0]
    v_pk_fma_f32 v[104:105], v[132:133], v[126:127], v[104:105] op_sel_hi:[1,0,1]
    v_pk_fma_f32 v[106:107], v[136:137], v[126:127], v[106:107] op_sel_hi:[1,0,1]
    v_cvt_pk_f16_f32 v96, v104, v105
    v_cvt_pk_f16_f32 v100, v106, v107
    s_waitcnt lgkmcnt(6)
    v_pk_mul_f32 v[104:105], v[138:139], v[20:21] op_sel_hi:[1,0]
    v_pk_mul_f32 v[106:107], v[138:139], v[42:43] op_sel_hi:[1,0]
    v_pk_mul_f32 v[108:109], v[138:139], v[22:23] op_sel_hi:[1,0]
    v_fract_f32 v105, v105
    v_exp_f32 v104, v104
    v_fract_f32 v107, v107
    v_exp_f32 v106, v106
    v_fract_f32 v109, v109
    v_exp_f32 v108, v108
    v_cos_f32 v120, v105
    v_sin_f32 v121, v105
    v_cos_f32 v122, v107
    v_sin_f32 v123, v107
    v_cos_f32 v124, v109
    v_sin_f32_e64 v126, v109
    v_pk_mul_f32 v[120:121], v[120:121], v[104:105] op_sel_hi:[1,0]
    v_pk_mul_f32 v[122:123], v[122:123], v[106:107] op_sel_hi:[1,0]
    v_mul_f32 v124, v124, v108
    v_mul_f32 v126, v126, v108
    v_cvt_pk_f16_f32 v89, v120, v121
    v_cvt_pk_f16_f32 v93, v122, v123
    v_pk_mul_f32 v[104:105], v[140:141], v[124:125] op_sel_hi:[1,0]
    v_pk_mul_f32 v[106:107], v[144:145], v[124:125] op_sel_hi:[1,0]
    v_pk_fma_f32 v[104:105], v[142:143], v[126:127], v[104:105] op_sel_hi:[1,0,1]
    v_pk_fma_f32 v[106:107], v[146:147], v[126:127], v[106:107] op_sel_hi:[1,0,1]
    v_cvt_pk_f16_f32 v97, v104, v105
    v_cvt_pk_f16_f32 v101, v106, v107
    s_waitcnt lgkmcnt(3)
    v_pk_mul_f32 v[104:105], v[148:149], v[20:21] op_sel_hi:[1,0]
    v_pk_mul_f32 v[106:107], v[148:149], v[42:43] op_sel_hi:[1,0]
    v_pk_mul_f32 v[108:109], v[148:149], v[22:23] op_sel_hi:[1,0]
    v_fract_f32 v105, v105
    v_exp_f32 v104, v104
    v_fract_f32 v107, v107
    v_exp_f32 v106, v106
    v_fract_f32 v109, v109
    v_exp_f32 v108, v108
    v_cos_f32 v120, v105
    v_sin_f32 v121, v105
    v_cos_f32 v122, v107
    v_sin_f32 v123, v107
    v_cos_f32 v124, v109
    v_sin_f32_e64 v126, v109
    v_pk_mul_f32 v[120:121], v[120:121], v[104:105] op_sel_hi:[1,0]
    v_pk_mul_f32 v[122:123], v[122:123], v[106:107] op_sel_hi:[1,0]
    v_mul_f32 v124, v124, v108
    v_mul_f32 v126, v126, v108
    v_cvt_pk_f16_f32 v90, v120, v121
    v_cvt_pk_f16_f32 v94, v122, v123
    v_pk_mul_f32 v[104:105], v[150:151], v[124:125] op_sel_hi:[1,0]
    v_pk_mul_f32 v[106:107], v[154:155], v[124:125] op_sel_hi:[1,0]
    v_pk_fma_f32 v[104:105], v[152:153], v[126:127], v[104:105] op_sel_hi:[1,0,1]
    v_pk_fma_f32 v[106:107], v[156:157], v[126:127], v[106:107] op_sel_hi:[1,0,1]
    v_cvt_pk_f16_f32 v98, v104, v105
    v_cvt_pk_f16_f32 v102, v106, v107
    s_waitcnt lgkmcnt(0)
    v_pk_mul_f32 v[104:105], v[158:159], v[20:21] op_sel_hi:[1,0]
    v_pk_mul_f32 v[106:107], v[158:159], v[42:43] op_sel_hi:[1,0]
    v_pk_mul_f32 v[108:109], v[158:159], v[22:23] op_sel_hi:[1,0]
    v_fract_f32 v105, v105
    v_exp_f32 v104, v104
    v_fract_f32 v107, v107
    v_exp_f32 v106, v106
    v_fract_f32 v109, v109
    v_exp_f32 v108, v108
    v_cos_f32 v120, v105
    v_sin_f32 v121, v105
    v_cos_f32 v122, v107
    v_sin_f32 v123, v107
    v_cos_f32 v124, v109
    v_sin_f32_e64 v126, v109
    v_pk_mul_f32 v[120:121], v[120:121], v[104:105] op_sel_hi:[1,0]
    v_pk_mul_f32 v[122:123], v[122:123], v[106:107] op_sel_hi:[1,0]
    v_mul_f32 v124, v124, v108
    v_mul_f32 v126, v126, v108
    v_cvt_pk_f16_f32 v91, v120, v121
    v_cvt_pk_f16_f32 v95, v122, v123
    v_pk_mul_f32 v[104:105], v[160:161], v[124:125] op_sel_hi:[1,0]
    v_pk_mul_f32 v[106:107], v[164:165], v[124:125] op_sel_hi:[1,0]
    v_pk_fma_f32 v[104:105], v[162:163], v[126:127], v[104:105] op_sel_hi:[1,0,1]
    v_pk_fma_f32 v[106:107], v[166:167], v[126:127], v[106:107] op_sel_hi:[1,0,1]
    v_cvt_pk_f16_f32 v99, v104, v105
    v_cvt_pk_f16_f32 v103, v106, v107
    s_nop 0
    v_mfma_f32_16x16x32_f16 v[48:51], v[88:91], v[96:99], v[48:51]
    v_mfma_f32_16x16x32_f16 v[52:55], v[92:95], v[96:99], v[52:55]
    v_mfma_f32_16x16x32_f16 v[56:59], v[88:91], v[100:103], v[56:59]
    v_mfma_f32_16x16x32_f16 v[60:63], v[92:95], v[100:103], v[60:63]
    v_add_u32 v41, 192, v41
    s_bitcmp1_b32 s53, 0
    s_cbranch_scc0 kab_knf
    s_nop 1
    v_pk_mul_f32 v[48:49], v[48:49], s[50:51] op_sel_hi:[1,0]
    v_pk_mul_f32 v[50:51], v[50:51], s[50:51] op_sel_hi:[1,0]
    v_pk_mul_f32 v[52:53], v[52:53], s[50:51] op_sel_hi:[1,0]
    v_pk_mul_f32 v[54:55], v[54:55], s[50:51] op_sel_hi:[1,0]
    v_mul_f32 v59, s50, v59
    v_mul_f32 v61, s50, v61
    v_mul_f32_e64 v63, s50, v63
    ds_write_b128 v25, v[48:51]
    ds_write_b64 v26, v[52:53]
    ds_write_b64 v27, v[54:55]
    ds_write_b32 v28, v59
    ds_write_b32 v18, v61
    ds_write_b32 v17, v63
    v_add_u32 v25, 12544, v25
    v_add_u32 v26, 12544, v26
    v_add_u32 v27, 12544, v27
    v_add_u32 v28, 12544, v28
    v_add_u32 v17, 12544, v17
    v_add_u32 v18, 12544, v18
    v_add_u32 v41, 1152, v41
    s_mov_b32 s50, s52
    s_waitcnt lgkmcnt(0)
kab_knf:
    s_add_u32 s53, s53, 1
    s_cmp_lt_u32 s53, 4
    s_cbranch_scc1 kab_kloop
    v_mov_b32 v10, 0
    s_waitcnt lgkmcnt(0)
    s_mov_b64 exec, 1
    ds_add_u32 v10, v248
    s_mov_b64 exec, -1
    v_lshlrev_b32 v8, 2, v0
    v_lshlrev_b32_e64 v9, 1, v0
adaLN_cond__ssm_conv_s4d__mixer_gmlp__prompt_kernel_w1:
    ds_read_b32 v11, v10
    s_waitcnt lgkmcnt(0)
    v_readfirstlane_b32 s90, v11
    s_nop 1
    s_cmp_lt_u32 s90, 4
    s_cbranch_scc1 adaLN_cond__ssm_conv_s4d__mixer_gmlp__prompt_kernel_w1
    ds_read_b32 v48, v8 offset:50572
    ds_read_b32 v49, v8 offset:53708
    ds_read_b32 v50, v8 offset:56844
    ds_read_b32 v51, v8 offset:59980
    ds_read_b32 v52, v8 offset:51596
    ds_read_b32 v53, v8 offset:54732
    ds_read_b32 v54, v8 offset:57868
    ds_read_b32 v55, v8 offset:61004
    ds_read_b32 v56, v8 offset:52620
    ds_read_b32 v57, v8 offset:55756
    ds_read_b32 v58, v8 offset:58892
    ds_read_b32 v59, v8 offset:62028
    v_add_u32 v12, 32768, v8
    s_waitcnt lgkmcnt(3)
    ds_read_b32 v60, v8 offset:63116
    ds_read_b32 v61, v12 offset:33484
    ds_read_b32 v62, v12 offset:36620
    ds_read_b32 v63, v12 offset:39756
    ds_read_b32 v64, v8 offset:64140
    ds_read_b32 v65, v12 offset:34508
    ds_read_b32 v66, v12 offset:37644
    ds_read_b32 v67, v12 offset:40780
    ds_read_b32 v68, v8 offset:65164
    ds_read_b32 v69, v12 offset:35532
    ds_read_b32 v70, v12 offset:38668
    ds_read_b32 v71, v12 offset:41804
    s_waitcnt lgkmcnt(12)
    v_add_f32 v48, v48, v49
    v_add_f32 v50, v50, v51
    v_add_f32 v52, v52, v53
    v_add_f32 v54, v54, v55
    v_add_f32 v56, v56, v57
    v_add_f32 v58, v58, v59
    v_add_f32 v48, v48, v50
    v_add_f32 v52, v52, v54
    v_add_f32 v56, v56, v58
    v_cvt_pk_bf16_f32 v48, v48, v48
    v_cvt_pk_bf16_f32 v52, v52, v52
    v_cvt_pk_bf16_f32 v56, v56, v56
    ds_write_b16 v9, v48 offset:46464
    ds_write_b16 v9, v52 offset:46976
    ds_write_b16 v9, v56 offset:47488
    s_waitcnt lgkmcnt(3)
    v_add_f32 v60, v60, v61
    v_add_f32 v62, v62, v63
    v_add_f32 v64, v64, v65
    v_add_f32 v66, v66, v67
    v_add_f32 v68, v68, v69
    v_add_f32 v70, v70, v71
    v_add_f32 v60, v60, v62
    v_add_f32 v64, v64, v66
    v_add_f32 v68, v68, v70
    v_cvt_pk_bf16_f32 v60, v60, v60
    v_cvt_pk_bf16_f32 v64, v64, v64
    v_cvt_pk_bf16_f32 v68, v68, v68
    ds_write_b16 v9, v60 offset:48000
    ds_write_b16 v9, v64 offset:48512
    ds_write_b16 v9, v68 offset:49024
    v_mov_b32 v10, 4
    s_waitcnt lgkmcnt(0)
    s_mov_b64 exec, 1
    ds_add_u32 v10, v248
    s_mov_b64 exec, -1
    s_lshr_b32 s40, s3, 1
    s_and_b32 s41, s3, 1
    v_and_b32 v12, 14, v6
    v_lshlrev_b32 v12, 1, v12
    v_lshlrev_b32 v13, 4, v7
    v_sub_u32 v12, v13, v12
    v_and_b32_e64 v13, 1, v6
    v_mul_u32_u24 v13, 4160, v13
    v_sub_u32_e64 v12, v12, v13
    s_mul_i32 s42, s40, 8320
    s_lshl_b32 s43, s41, 8
    s_sub_u32 s42, s42, s43
    s_add_u32 s42, s42, 7836
    v_add_u32_e64 v20, s42, v12
    v_subrev_u32 v21, 1024, v20
    v_subrev_u32 v22, 2048, v20
    v_subrev_u32 v23, 3072, v20
    v_lshlrev_b32_e64 v12, 5, v6
    v_lshl_add_u32 v12, v7, 4, v12
    s_mul_i32 s42, s40, 4608
    s_sub_u32 s42, s42, s43
    s_add_u32 s42, s42, 17248
    v_add_u32 v24, s42, v12
    v_lshlrev_b32_e64 v12, 5, v6
    v_lshl_add_u32 v12, v7, 3, v12
    s_lshl_b32 s43, s41, 11
    s_mul_i32 s42, s40, 4608
    s_add_u32 s42, s42, s43
    s_add_u32 s42, s42, 17280
    v_add_u32 v25, s42, v12
    v_lshlrev_b32 v12, 6, v6
    v_lshrrev_b32_e64 v13, 1, v7
    v_lshl_add_u32 v12, v13, 5, v12
    v_and_b32_e64 v13, 1, v7
    v_lshl_add_u32 v12, v13, 3, v12
    s_lshl_b32 s42, s40, 4
    s_lshl_b32 s45, s41, 12
    s_add_u32 s42, s42, s45
    s_add_u32 s42, s42, 25984
    v_add_u32 v26, s42, v12
    v_lshrrev_b32 v12, 1, v6
    v_lshlrev_b32 v12, 3, v12
    v_and_b32_e64 v13, 1, v7
    v_lshl_add_u32 v12, v13, 2, v12
    v_and_b32_e64 v13, 1, v6
    v_lshl_add_u32 v12, v13, 1, v12
    v_lshrrev_b32 v13, 1, v7
    v_add_u32 v12, v12, v13
    v_lshrrev_b32 v13, 4, v12
    v_and_b32 v12, 15, v12
    v_lshlrev_b32_e64 v27, 3, v12
    v_lshl_add_u32 v27, v13, 16, v27
    s_lshl_b32 s44, s40, 1
    s_add_u32 s44, s44, s88
    s_lshl_b32 s44, s44, 7
    s_lshl_b32 s45, s41, 20
    s_add_u32 s44, s44, s45
    s_lshl_b32 s42, s3, 12
    s_add_u32 s42, s42, 34176
    v_add_u32 v28, s42, v3
    s_xor_b32 s42, s3, 1
    s_lshl_b32 s42, s42, 12
    s_add_u32 s42, s42, 34176
    v_add_u32 v29, s42, v3
    s_add_u32 s16, s36, 1048576
    s_addc_u32 s17, s37, 0
    s_and_b32 s17, s17, 0xffff
    s_mov_b32 s18, 2097152
    s_mov_b32 s19, 0x00020000
    v_lshlrev_b32 v12, 16, v111
    s_nop 0
    v_readlane_b32 s47, v12, 0
    v_readlane_b32 s48, v12, 32
    s_cmp_eq_u32 s40, 0
    s_nop 0
    s_cselect_b32 s48, s47, s48
adaLN_cond__ssm_conv_s4d__mixer_gmlp__prompt_kernel_w2:
    ds_read_b32 v11, v10
    s_waitcnt lgkmcnt(0)
    v_readfirstlane_b32 s90, v11
    s_nop 1
    s_cmp_lt_u32 s90, 4
    s_cbranch_scc1 adaLN_cond__ssm_conv_s4d__mixer_gmlp__prompt_kernel_w2
    ds_read_u16 v48, v30 offset:46464
    ds_read_u16 v49, v31 offset:46464
    ds_read_u16 v50, v32 offset:46464
    ds_read_u16 v51, v33 offset:46464
    ds_read_u16 v52, v34 offset:46464
    ds_read_u16 v53, v35 offset:46464
    ds_read_u16 v54, v36 offset:46464
    ds_read_u16 v55, v37 offset:46464
    ds_read_u16 v56, v38 offset:46464
    s_waitcnt lgkmcnt(6)
    ds_read_u16 v58, v30 offset:48000
    ds_read_u16 v59, v31 offset:48000
    ds_read_u16 v60, v32 offset:48000
    ds_read_u16 v61, v33 offset:48000
    ds_read_u16 v62, v34 offset:48000
    ds_read_u16 v63, v35 offset:48000
    ds_read_u16 v64, v36 offset:48000
    ds_read_u16 v65, v37 offset:48000
    ds_read_u16 v66, v38 offset:48000
    v_lshlrev_b32 v8, 4, v0
    v_mov_b32 v72, 0
    v_mov_b32 v73, 0
    v_mov_b32 v74, 0
    v_mov_b32_e64 v75, 0
    v_cmp_eq_u32 vcc, 255, v0
    s_waitcnt lgkmcnt(9)
    s_nop 0
    v_cndmask_b32 v56, v56, v72, vcc
    s_nop 0
    v_lshl_or_b32 v80, v49, 16, v48
    v_lshl_or_b32 v81, v51, 16, v50
    v_lshl_or_b32 v82, v53, 16, v52
    v_lshl_or_b32 v83, v55, 16, v54
    ds_write_b128 v8, v[80:83] offset:128
    v_lshl_or_b32 v84, v50, 16, v49
    v_lshl_or_b32 v85, v52, 16, v51
    v_lshl_or_b32 v86, v54, 16, v53
    v_lshl_or_b32 v87, v56, 16, v55
    ds_write_b128 v8, v[84:87] offset:4288
    s_waitcnt lgkmcnt(2)
    v_cndmask_b32 v66, v66, v72, vcc
    v_lshl_or_b32 v88, v59, 16, v58
    v_lshl_or_b32 v89, v61, 16, v60
    v_lshl_or_b32 v90, v63, 16, v62
    v_lshl_or_b32 v91, v65, 16, v64
    ds_write_b128 v8, v[88:91] offset:8448
    v_lshl_or_b32 v92, v60, 16, v59
    v_lshl_or_b32 v93, v62, 16, v61
    v_lshl_or_b32 v94, v64, 16, v63
    v_lshl_or_b32 v95, v66, 16, v65
    ds_write_b128 v8, v[92:95] offset:12608
    v_mov_b32 v44, 0
    v_mov_b32 v45, 0
    v_mov_b32 v46, 0
    v_mov_b32 v47, 0
    v_mov_b32 v48, 0
    v_mov_b32 v49, 0
    v_mov_b32 v50, 0
    v_mov_b32 v51, 0
    v_mov_b32 v52, 0
    v_mov_b32 v53, 0
    v_mov_b32 v54, 0
    v_mov_b32 v55, 0
    v_mov_b32 v56, 0
    v_mov_b32 v57, 0
    v_mov_b32 v58, 0
    v_mov_b32 v59, 0
    v_mov_b32 v60, 0
    v_mov_b32 v61, 0
    v_mov_b32 v62, 0
    v_mov_b32 v63, 0
    v_mov_b32 v64, 0
    v_mov_b32 v65, 0
    v_mov_b32 v66, 0
    v_mov_b32 v67, 0
    v_mov_b32 v68, 0
    v_mov_b32 v69, 0
    v_mov_b32 v70, 0
    v_mov_b32 v71, 0
    v_mov_b32 v72, 0
    v_mov_b32 v73, 0
    v_mov_b32 v74, 0
    v_mov_b32 v75, 0
    s_waitcnt lgkmcnt(0)
    s_barrier
    s_lshl_b32 s42, s40, 2
    v_mov_b32 v12, s42
    ds_read_b32 v12, v12 offset:80
    ds_read2_b32 v[76:77], v20 offset0:128 offset1:129
    ds_read2_b32 v[78:79], v20 offset0:130 offset1:131
    ds_read_b128 v[176:179], v24 offset:0
    ds_read2_b32 v[80:81], v20 offset0:0 offset1:1
    ds_read2_b32 v[82:83], v20 offset0:2 offset1:3
    ds_read_b128 v[180:183], v24 offset:512
    ds_read2_b32 v[84:85], v21 offset0:128 offset1:129
    ds_read2_b32 v[86:87], v21 offset0:130 offset1:131
    ds_read_b128 v[184:187], v24 offset:1024
    ds_read2_b32 v[88:89], v21 offset0:0 offset1:1
    ds_read2_b32 v[90:91], v21 offset0:2 offset1:3
    ds_read_b128 v[188:191], v24 offset:1536
    ds_read2_b32 v[92:93], v22 offset0:128 offset1:129
    ds_read2_b32 v[94:95], v22 offset0:130 offset1:131
    ds_read_b128 v[192:195], v24 offset:2048
    ds_read2_b32 v[96:97], v22 offset0:0 offset1:1
    ds_read2_b32 v[98:99], v22 offset0:2 offset1:3
    ds_read_b128 v[196:199], v24 offset:2560
    ds_read2_b32 v[100:101], v23 offset0:128 offset1:129
    ds_read2_b32 v[102:103], v23 offset0:130 offset1:131
    ds_read_b128 v[200:203], v24 offset:3072
    ds_read2_b32 v[104:105], v23 offset0:0 offset1:1
    ds_read2_b32 v[106:107], v23 offset0:2 offset1:3
    ds_read_b128 v[204:207], v24 offset:3584
    v_subrev_u32 v20, 64, v20
    v_subrev_u32 v21, 64, v21
    v_subrev_u32 v22, 64, v22
    v_subrev_u32 v23, 64, v23
    v_subrev_u32 v24, 64, v24
    s_mov_b32 s50, 0
    s_waitcnt lgkmcnt(0)
    v_readfirstlane_b32 s46, v12
kab_cloop:
    s_waitcnt lgkmcnt(0)
    s_nop 0
    v_mfma_f32_16x16x32_bf16 v[44:47], v[76:79], v[176:179], v[44:47]
    ds_read2_b32 v[144:145], v20 offset0:128 offset1:129
    v_mfma_f32_16x16x32_bf16 v[48:51], v[76:79], v[180:183], v[48:51]
    ds_read2_b32 v[146:147], v20 offset0:130 offset1:131
    v_mfma_f32_16x16x32_bf16 v[48:51], v[80:83], v[176:179], v[48:51]
    ds_read_b128 v[208:211], v24 offset:0
    v_mfma_f32_16x16x32_bf16 v[52:55], v[80:83], v[180:183], v[52:55]
    ds_read2_b32 v[148:149], v20 offset0:0 offset1:1
    v_mfma_f32_16x16x32_bf16 v[52:55], v[76:79], v[184:187], v[52:55]
    ds_read2_b32 v[150:151], v20 offset0:2 offset1:3
    v_mfma_f32_16x16x32_bf16 v[52:55], v[84:87], v[176:179], v[52:55]
    ds_read_b128 v[212:215], v24 offset:512
    v_mfma_f32_16x16x32_bf16 v[56:59], v[80:83], v[184:187], v[56:59]
    ds_read2_b32 v[152:153], v21 offset0:128 offset1:129
    v_mfma_f32_16x16x32_bf16 v[56:59], v[84:87], v[180:183], v[56:59]
    ds_read2_b32 v[154:155], v21 offset0:130 offset1:131
    v_mfma_f32_16x16x32_bf16 v[60:63], v[84:87], v[184:187], v[60:63]
    ds_read_b128 v[216:219], v24 offset:1024
    v_mfma_f32_16x16x32_bf16 v[56:59], v[76:79], v[188:191], v[56:59]
    ds_read2_b32 v[156:157], v21 offset0:0 offset1:1
    v_mfma_f32_16x16x32_bf16 v[56:59], v[88:91], v[176:179], v[56:59]
    ds_read2_b32 v[158:159], v21 offset0:2 offset1:3
    v_mfma_f32_16x16x32_bf16 v[60:63], v[80:83], v[188:191], v[60:63]
    ds_read_b128 v[220:223], v24 offset:1536
    v_mfma_f32_16x16x32_bf16 v[60:63], v[88:91], v[180:183], v[60:63]
    ds_read2_b32 v[160:161], v22 offset0:128 offset1:129
    v_mfma_f32_16x16x32_bf16 v[64:67], v[84:87], v[188:191], v[64:67]
    ds_read2_b32 v[162:163], v22 offset0:130 offset1:131
    v_mfma_f32_16x16x32_bf16 v[64:67], v[88:91], v[184:187], v[64:67]
    ds_read_b128 v[224:227], v24 offset:2048
    v_mfma_f32_16x16x32_bf16 v[68:71], v[88:91], v[188:191], v[68:71]
    ds_read2_b32 v[164:165], v22 offset0:0 offset1:1
    v_mfma_f32_16x16x32_bf16 v[60:63], v[76:79], v[192:195], v[60:63]
    ds_read2_b32 v[166:167], v22 offset0:2 offset1:3
    v_mfma_f32_16x16x32_bf16 v[60:63], v[92:95], v[176:179], v[60:63]
    ds_read_b128 v[228:231], v24 offset:2560
    v_mfma_f32_16x16x32_bf16 v[64:67], v[80:83], v[192:195], v[64:67]
    ds_read2_b32 v[168:169], v23 offset0:128 offset1:129
    v_mfma_f32_16x16x32_bf16 v[64:67], v[92:95], v[180:183], v[64:67]
    ds_read2_b32 v[170:171], v23 offset0:130 offset1:131
    v_mfma_f32_16x16x32_bf16 v[68:71], v[84:87], v[192:195], v[68:71]
    ds_read_b128 v[232:235], v24 offset:3072
    v_mfma_f32_16x16x32_bf16 v[68:71], v[92:95], v[184:187], v[68:71]
    ds_read2_b32 v[172:173], v23 offset0:0 offset1:1
    v_mfma_f32_16x16x32_bf16 v[72:75], v[88:91], v[192:195], v[72:75]
    ds_read2_b32 v[174:175], v23 offset0:2 offset1:3
    v_mfma_f32_16x16x32_bf16 v[72:75], v[92:95], v[188:191], v[72:75]
    ds_read_b128 v[236:239], v24 offset:3584
    v_mfma_f32_16x16x32_bf16 v[64:67], v[76:79], v[196:199], v[64:67]
    v_subrev_u32_e64 v20, 64, v20
    v_mfma_f32_16x16x32_bf16 v[64:67], v[96:99], v[176:179], v[64:67]
    v_subrev_u32_e64 v21, 64, v21
    v_mfma_f32_16x16x32_bf16 v[68:71], v[80:83], v[196:199], v[68:71]
    v_subrev_u32_e64 v22, 64, v22
    v_mfma_f32_16x16x32_bf16 v[68:71], v[96:99], v[180:183], v[68:71]
    v_subrev_u32_e64 v23, 64, v23
    v_mfma_f32_16x16x32_bf16 v[72:75], v[84:87], v[196:199], v[72:75]
    v_subrev_u32_e64 v24, 64, v24
    v_mfma_f32_16x16x32_bf16 v[72:75], v[96:99], v[184:187], v[72:75]
    v_mfma_f32_16x16x32_bf16 v[68:71], v[76:79], v[200:203], v[68:71]
    v_mfma_f32_16x16x32_bf16 v[68:71], v[100:103], v[176:179], v[68:71]
    v_mfma_f32_16x16x32_bf16 v[72:75], v[80:83], v[200:203], v[72:75]
    v_mfma_f32_16x16x32_bf16 v[72:75], v[100:103], v[180:183], v[72:75]
    v_mfma_f32_16x16x32_bf16 v[72:75], v[76:79], v[204:207], v[72:75]
    v_mfma_f32_16x16x32_bf16 v[72:75], v[104:107], v[176:179], v[72:75]
    s_waitcnt lgkmcnt(0)
    s_nop 0
    v_mfma_f32_16x16x32_bf16 v[44:47], v[144:147], v[208:211], v[44:47]
    ds_read2_b32 v[76:77], v20 offset0:128 offset1:129
    v_mfma_f32_16x16x32_bf16 v[48:51], v[144:147], v[212:215], v[48:51]
    ds_read2_b32 v[78:79], v20 offset0:130 offset1:131
    v_mfma_f32_16x16x32_bf16 v[48:51], v[148:151], v[208:211], v[48:51]
    ds_read_b128 v[176:179], v24 offset:0
    v_mfma_f32_16x16x32_bf16 v[52:55], v[148:151], v[212:215], v[52:55]
    ds_read2_b32 v[80:81], v20 offset0:0 offset1:1
    v_mfma_f32_16x16x32_bf16 v[52:55], v[144:147], v[216:219], v[52:55]
    ds_read2_b32 v[82:83], v20 offset0:2 offset1:3
    v_mfma_f32_16x16x32_bf16 v[52:55], v[152:155], v[208:211], v[52:55]
    ds_read_b128 v[180:183], v24 offset:512
    v_mfma_f32_16x16x32_bf16 v[56:59], v[148:151], v[216:219], v[56:59]
    ds_read2_b32 v[84:85], v21 offset0:128 offset1:129
    v_mfma_f32_16x16x32_bf16 v[56:59], v[152:155], v[212:215], v[56:59]
    ds_read2_b32 v[86:87], v21 offset0:130 offset1:131
    v_mfma_f32_16x16x32_bf16 v[60:63], v[152:155], v[216:219], v[60:63]
    ds_read_b128 v[184:187], v24 offset:1024
    v_mfma_f32_16x16x32_bf16 v[56:59], v[144:147], v[220:223], v[56:59]
    ds_read2_b32 v[88:89], v21 offset0:0 offset1:1
    v_mfma_f32_16x16x32_bf16 v[56:59], v[156:159], v[208:211], v[56:59]
    ds_read2_b32 v[90:91], v21 offset0:2 offset1:3
    v_mfma_f32_16x16x32_bf16 v[60:63], v[148:151], v[220:223], v[60:63]
    ds_read_b128 v[188:191], v24 offset:1536
    v_mfma_f32_16x16x32_bf16 v[60:63], v[156:159], v[212:215], v[60:63]
    ds_read2_b32 v[92:93], v22 offset0:128 offset1:129
    v_mfma_f32_16x16x32_bf16 v[64:67], v[152:155], v[220:223], v[64:67]
    ds_read2_b32 v[94:95], v22 offset0:130 offset1:131
    v_mfma_f32_16x16x32_bf16 v[64:67], v[156:159], v[216:219], v[64:67]
    ds_read_b128 v[192:195], v24 offset:2048
    v_mfma_f32_16x16x32_bf16 v[68:71], v[156:159], v[220:223], v[68:71]
    ds_read2_b32 v[96:97], v22 offset0:0 offset1:1
    v_mfma_f32_16x16x32_bf16 v[60:63], v[144:147], v[224:227], v[60:63]
    ds_read2_b32 v[98:99], v22 offset0:2 offset1:3
    v_mfma_f32_16x16x32_bf16 v[60:63], v[160:163], v[208:211], v[60:63]
    ds_read_b128 v[196:199], v24 offset:2560
    v_mfma_f32_16x16x32_bf16 v[64:67], v[148:151], v[224:227], v[64:67]
    ds_read2_b32 v[100:101], v23 offset0:128 offset1:129
    v_mfma_f32_16x16x32_bf16 v[64:67], v[160:163], v[212:215], v[64:67]
    ds_read2_b32 v[102:103], v23 offset0:130 offset1:131
    v_mfma_f32_16x16x32_bf16 v[68:71], v[152:155], v[224:227], v[68:71]
    ds_read_b128 v[200:203], v24 offset:3072
    v_mfma_f32_16x16x32_bf16 v[68:71], v[160:163], v[216:219], v[68:71]
    ds_read2_b32 v[104:105], v23 offset0:0 offset1:1
    v_mfma_f32_16x16x32_bf16 v[72:75], v[156:159], v[224:227], v[72:75]
    ds_read2_b32 v[106:107], v23 offset0:2 offset1:3
    v_mfma_f32_16x16x32_bf16 v[72:75], v[160:163], v[220:223], v[72:75]
    ds_read_b128 v[204:207], v24 offset:3584
    v_mfma_f32_16x16x32_bf16 v[64:67], v[144:147], v[228:231], v[64:67]
    v_subrev_u32_e64 v20, 64, v20
    v_mfma_f32_16x16x32_bf16 v[64:67], v[164:167], v[208:211], v[64:67]
    v_subrev_u32_e64 v21, 64, v21
    v_mfma_f32_16x16x32_bf16 v[68:71], v[148:151], v[228:231], v[68:71]
    v_subrev_u32_e64 v22, 64, v22
    v_mfma_f32_16x16x32_bf16 v[68:71], v[164:167], v[212:215], v[68:71]
    v_subrev_u32_e64 v23, 64, v23
    v_mfma_f32_16x16x32_bf16 v[72:75], v[152:155], v[228:231], v[72:75]
    v_subrev_u32_e64 v24, 64, v24
    v_mfma_f32_16x16x32_bf16 v[72:75], v[164:167], v[216:219], v[72:75]
    v_mfma_f32_16x16x32_bf16 v[68:71], v[144:147], v[232:235], v[68:71]
    v_mfma_f32_16x16x32_bf16 v[68:71], v[168:171], v[208:211], v[68:71]
    v_mfma_f32_16x16x32_bf16 v[72:75], v[148:151], v[232:235], v[72:75]
    v_mfma_f32_16x16x32_bf16 v[72:75], v[168:171], v[212:215], v[72:75]
    v_mfma_f32_16x16x32_bf16 v[72:75], v[144:147], v[236:239], v[72:75]
    v_mfma_f32_16x16x32_bf16 v[72:75], v[172:175], v[208:211], v[72:75]
    s_add_u32 s50, s50, 1
    s_cmp_lt_u32 s50, 2
    s_cbranch_scc1 kab_cloop
    s_waitcnt lgkmcnt(0)
    s_cmp_eq_u32 s41, 0
    s_cbranch_scc0 adaLN_cond__ssm_conv_s4d__mixer_gmlp__prompt_kernel_L3
    ds_write_b128 v28, v[60:63] offset:0
    ds_write_b128 v28, v[64:67] offset:1024
    ds_write_b128 v28, v[68:71] offset:2048
    ds_write_b128 v28, v[72:75] offset:3072
    s_branch adaLN_cond__ssm_conv_s4d__mixer_gmlp__prompt_kernel_L4
adaLN_cond__ssm_conv_s4d__mixer_gmlp__prompt_kernel_L3:
    ds_write_b128 v28, v[44:47] offset:0
    ds_write_b128 v28, v[48:51] offset:1024
    ds_write_b128 v28, v[52:55] offset:2048
    ds_write_b128 v28, v[56:59] offset:3072
    v_mov_b64 v[44:45], v[60:61]
    v_mov_b64 v[46:47], v[62:63]
    v_mov_b64 v[48:49], v[64:65]
    v_mov_b64 v[50:51], v[66:67]
    v_mov_b64 v[52:53], v[68:69]
    v_mov_b64 v[54:55], v[70:71]
    v_mov_b64 v[56:57], v[72:73]
    v_mov_b64 v[58:59], v[74:75]
adaLN_cond__ssm_conv_s4d__mixer_gmlp__prompt_kernel_L4:
    s_lshl_b32 s42, s40, 2
    s_add_u32 s42, s42, 12
    v_mov_b32 v10, s42
    s_waitcnt lgkmcnt(0)
    s_mov_b64 exec, 1
    ds_add_u32 v10, v248
    s_mov_b64 exec, -1
    s_nop 0
    ds_read_b64 v[76:77], v25 offset:0
    ds_read_b64 v[84:85], v26 offset:0
    ds_read_b64 v[78:79], v25 offset:512
    ds_read_b64 v[86:87], v26 offset:1024
    ds_read_b64 v[80:81], v25 offset:1024
    ds_read_b64 v[88:89], v26 offset:2048
    ds_read_b64 v[82:83], v25 offset:1536
    ds_read_b64 v[90:91], v26 offset:3072
    s_waitcnt lgkmcnt(0)
    v_lshlrev_b32 v144, 16, v76
    v_and_b32 v145, s97, v76
    v_lshlrev_b32 v146, 16, v77
    v_and_b32 v147, s97, v77
    v_lshlrev_b32 v148, 16, v78
    v_and_b32 v149, s97, v78
    v_lshlrev_b32 v150, 16, v79
    v_and_b32 v151, s97, v79
    v_lshlrev_b32 v152, 16, v80
    v_and_b32 v153, s97, v80
    v_lshlrev_b32 v154, 16, v81
    v_and_b32 v155, s97, v81
    v_lshlrev_b32 v156, 16, v82
    v_and_b32 v157, s97, v82
    v_lshlrev_b32 v158, 16, v83
    v_and_b32_e64 v159, s97, v83
    v_pk_mul_f32 v[144:145], v[144:145], s[48:49] op_sel_hi:[1,0]
    v_pk_mul_f32 v[146:147], v[146:147], s[48:49] op_sel_hi:[1,0]
    v_pk_mul_f32 v[148:149], v[148:149], s[48:49] op_sel_hi:[1,0]
    v_pk_mul_f32 v[150:151], v[150:151], s[48:49] op_sel_hi:[1,0]
    v_pk_mul_f32 v[152:153], v[152:153], s[48:49] op_sel_hi:[1,0]
    v_pk_mul_f32 v[154:155], v[154:155], s[48:49] op_sel_hi:[1,0]
    v_pk_mul_f32 v[156:157], v[156:157], s[48:49] op_sel_hi:[1,0]
    v_pk_mul_f32 v[158:159], v[158:159], s[48:49] op_sel_hi:[1,0]
    v_cvt_pk_bf16_f32 v76, v144, v145
    v_cvt_pk_bf16_f32 v77, v146, v147
    v_cvt_pk_bf16_f32 v78, v148, v149
    v_cvt_pk_bf16_f32 v79, v150, v151
    v_cvt_pk_bf16_f32 v80, v152, v153
    v_cvt_pk_bf16_f32 v81, v154, v155
    v_cvt_pk_bf16_f32 v82, v156, v157
    v_cvt_pk_bf16_f32 v83, v158, v159
adaLN_cond__ssm_conv_s4d__mixer_gmlp__prompt_kernel_w5:
    ds_read_b32 v11, v10
    s_waitcnt lgkmcnt(0)
    v_readfirstlane_b32 s90, v11
    s_nop 1
    s_cmp_lt_u32 s90, 2
    s_cbranch_scc1 adaLN_cond__ssm_conv_s4d__mixer_gmlp__prompt_kernel_w5
    ds_read_b128 v[60:63], v29 offset:0
    ds_read_b128 v[64:67], v29 offset:1024
    ds_read_b128 v[68:71], v29 offset:2048
    ds_read_b128 v[72:75], v29 offset:3072
    v_lshlrev_b32 v144, 16, v76
    v_and_b32 v145, s97, v76
    v_lshlrev_b32 v160, 16, v84
    v_and_b32 v161, s97, v84
    v_lshlrev_b32 v146, 16, v77
    v_and_b32 v147, s97, v77
    v_lshlrev_b32 v162, 16, v85
    v_and_b32 v163, s97, v85
    v_lshlrev_b32 v148, 16, v78
    v_and_b32 v149, s97, v78
    v_lshlrev_b32 v164, 16, v86
    v_and_b32 v165, s97, v86
    v_lshlrev_b32 v150, 16, v79
    v_and_b32 v151, s97, v79
    v_lshlrev_b32 v166, 16, v87
    v_and_b32 v167, s97, v87
    v_lshlrev_b32 v152, 16, v80
    v_and_b32 v153, s97, v80
    v_lshlrev_b32 v168, 16, v88
    v_and_b32 v169, s97, v88
    v_lshlrev_b32 v154, 16, v81
    v_and_b32 v155, s97, v81
    v_lshlrev_b32 v170, 16, v89
    v_and_b32 v171, s97, v89
    v_lshlrev_b32 v156, 16, v82
    v_and_b32 v157, s97, v82
    v_lshlrev_b32 v172, 16, v90
    v_and_b32 v173, s97, v90
    v_lshlrev_b32 v158, 16, v83
    v_and_b32 v159, s97, v83
    v_lshlrev_b32 v174, 16, v91
    v_and_b32 v175, s97, v91
    s_waitcnt lgkmcnt(0)
    v_pk_add_f32 v[44:45], v[44:45], v[60:61]
    v_pk_add_f32 v[46:47], v[46:47], v[62:63]
    v_pk_add_f32 v[48:49], v[48:49], v[64:65]
    v_pk_add_f32 v[50:51], v[50:51], v[66:67]
    v_pk_add_f32 v[52:53], v[52:53], v[68:69]
    v_pk_add_f32 v[54:55], v[54:55], v[70:71]
    v_pk_add_f32 v[56:57], v[56:57], v[72:73]
    v_pk_add_f32 v[58:59], v[58:59], v[74:75]
    v_cvt_pk_bf16_f32 v76, v44, v45
    v_cvt_pk_bf16_f32 v77, v46, v47
    v_cvt_pk_bf16_f32 v78, v48, v49
    v_cvt_pk_bf16_f32 v79, v50, v51
    v_cvt_pk_bf16_f32 v80, v52, v53
    v_cvt_pk_bf16_f32 v81, v54, v55
    v_cvt_pk_bf16_f32 v82, v56, v57
    v_cvt_pk_bf16_f32 v83, v58, v59
    v_lshlrev_b32 v44, 16, v76
    v_and_b32 v45, s97, v76
    v_lshlrev_b32 v46, 16, v77
    v_and_b32 v47, s97, v77
    v_lshlrev_b32 v48, 16, v78
    v_and_b32 v49, s97, v78
    v_lshlrev_b32 v50, 16, v79
    v_and_b32 v51, s97, v79
    v_lshlrev_b32 v52, 16, v80
    v_and_b32 v53, s97, v80
    v_lshlrev_b32 v54, 16, v81
    v_and_b32 v55, s97, v81
    v_lshlrev_b32 v56, 16, v82
    v_and_b32 v57, s97, v82
    v_lshlrev_b32 v58, 16, v83
    v_and_b32 v59, s97, v83
    v_pk_add_f32 v[44:45], v[44:45], v[144:145]
    v_pk_add_f32 v[46:47], v[46:47], v[146:147]
    v_pk_add_f32 v[48:49], v[48:49], v[148:149]
    v_pk_add_f32 v[50:51], v[50:51], v[150:151]
    v_pk_add_f32 v[52:53], v[52:53], v[152:153]
    v_pk_add_f32 v[54:55], v[54:55], v[154:155]
    v_pk_add_f32 v[56:57], v[56:57], v[156:157]
    v_pk_add_f32 v[58:59], v[58:59], v[158:159]
    v_cvt_pk_bf16_f32 v76, v44, v45
    v_cvt_pk_bf16_f32 v77, v46, v47
    v_cvt_pk_bf16_f32 v78, v48, v49
    v_cvt_pk_bf16_f32 v79, v50, v51
    v_cvt_pk_bf16_f32 v80, v52, v53
    v_cvt_pk_bf16_f32 v81, v54, v55
    v_cvt_pk_bf16_f32 v82, v56, v57
    v_cvt_pk_bf16_f32 v83, v58, v59
    v_lshlrev_b32 v44, 16, v76
    v_and_b32 v45, s97, v76
    v_lshlrev_b32 v46, 16, v77
    v_and_b32 v47, s97, v77
    v_lshlrev_b32 v48, 16, v78
    v_and_b32 v49, s97, v78
    v_lshlrev_b32 v50, 16, v79
    v_and_b32 v51, s97, v79
    v_lshlrev_b32 v52, 16, v80
    v_and_b32 v53, s97, v80
    v_lshlrev_b32 v54, 16, v81
    v_and_b32 v55, s97, v81
    v_lshlrev_b32 v56, 16, v82
    v_and_b32 v57, s97, v82
    v_lshlrev_b32 v58, 16, v83
    v_and_b32 v59, s97, v83
    v_pk_mul_f32 v[44:45], v[44:45], s[46:47] op_sel:[0,0] op_sel_hi:[1,0]
    v_pk_mul_f32 v[46:47], v[46:47], s[46:47] op_sel:[0,0] op_sel_hi:[1,0]
    v_pk_mul_f32 v[48:49], v[48:49], s[46:47] op_sel:[0,0] op_sel_hi:[1,0]
    v_pk_mul_f32 v[50:51], v[50:51], s[46:47] op_sel:[0,0] op_sel_hi:[1,0]
    v_pk_mul_f32 v[52:53], v[52:53], s[46:47] op_sel:[0,0] op_sel_hi:[1,0]
    v_pk_mul_f32 v[54:55], v[54:55], s[46:47] op_sel:[0,0] op_sel_hi:[1,0]
    v_pk_mul_f32 v[56:57], v[56:57], s[46:47] op_sel:[0,0] op_sel_hi:[1,0]
    v_pk_mul_f32 v[58:59], v[58:59], s[46:47] op_sel:[0,0] op_sel_hi:[1,0]
    v_cvt_pk_bf16_f32 v76, v44, v45
    v_cvt_pk_bf16_f32 v77, v46, v47
    v_cvt_pk_bf16_f32 v78, v48, v49
    v_cvt_pk_bf16_f32 v79, v50, v51
    v_cvt_pk_bf16_f32 v80, v52, v53
    v_cvt_pk_bf16_f32 v81, v54, v55
    v_cvt_pk_bf16_f32 v82, v56, v57
    v_cvt_pk_bf16_f32 v83, v58, v59
    v_lshlrev_b32 v44, 16, v76
    v_and_b32 v45, s97, v76
    v_lshlrev_b32 v46, 16, v77
    v_and_b32 v47, s97, v77
    v_lshlrev_b32 v48, 16, v78
    v_and_b32 v49, s97, v78
    v_lshlrev_b32 v50, 16, v79
    v_and_b32 v51, s97, v79
    v_lshlrev_b32 v52, 16, v80
    v_and_b32 v53, s97, v80
    v_lshlrev_b32 v54, 16, v81
    v_and_b32 v55, s97, v81
    v_lshlrev_b32 v56, 16, v82
    v_and_b32 v57, s97, v82
    v_lshlrev_b32 v58, 16, v83
    v_and_b32 v59, s97, v83
    v_pk_add_f32 v[44:45], v[44:45], v[160:161]
    v_pk_add_f32 v[46:47], v[46:47], v[162:163]
    v_pk_add_f32 v[48:49], v[48:49], v[164:165]
    v_pk_add_f32 v[50:51], v[50:51], v[166:167]
    v_pk_add_f32 v[52:53], v[52:53], v[168:169]
    v_pk_add_f32 v[54:55], v[54:55], v[170:171]
    v_pk_add_f32 v[56:57], v[56:57], v[172:173]
    v_pk_add_f32 v[58:59], v[58:59], v[174:175]
    v_cvt_pk_bf16_f32 v76, v44, v45
    v_cvt_pk_bf16_f32 v77, v46, v47
    buffer_store_dwordx2 v[76:77], v27, s[16:19], s44 offen sc1
    s_add_u32 s44, s44, 262144
    v_cvt_pk_bf16_f32 v78, v48, v49
    v_cvt_pk_bf16_f32 v79, v50, v51
    buffer_store_dwordx2 v[78:79], v27, s[16:19], s44 offen sc1
    s_add_u32 s44, s44, 262144
    v_cvt_pk_bf16_f32 v80, v52, v53
    v_cvt_pk_bf16_f32 v81, v54, v55
    buffer_store_dwordx2 v[80:81], v27, s[16:19], s44 offen sc1
    s_add_u32 s44, s44, 262144
    v_cvt_pk_bf16_f32 v82, v56, v57
    v_cvt_pk_bf16_f32 v83, v58, v59
    buffer_store_dwordx2 v[82:83], v27, s[16:19], s44 offen sc1
    s_add_u32 s44, s44, 262144
    s_branch kcd_entry
kab_h:
    s_setprio 2
    v_and_b32 v0, 255, v0
    v_mov_b32 v8, 0
    v_mov_b32 v9, 0
    v_mov_b32 v10, 0
    v_mov_b32 v11, 0
    s_cmp_lg_u32 s3, 0
    s_cbranch_scc1 kab_h0
    v_lshrrev_b32_e64 v7, 5, v1
    v_mul_u32_u24 v7, 4608, v7
    v_and_b32_e64 v6, 31, v1
    v_lshl_add_u32 v7, v6, 4, v7
    ds_write_b128 v7, v[8:11] offset:16768
    v_lshrrev_b32_e64 v6, 2, v1
    v_mul_u32_u24 v7, 4160, v6
    v_and_b32_e64 v6, 3, v1
    v_lshl_add_u32 v7, v6, 4, v7
    v_add_u32 v7, 4224, v7
    v_lshlrev_b32 v6, 4, v6
    v_cmp_gt_u32 vcc, 16, v1
    s_nop 1
    v_cndmask_b32 v7, v6, v7, vcc
    ds_write_b128 v7, v[8:11]
kab_h0:
    s_lshl_b32 s10, s2, 13
    s_add_u32 s38, s10, 4096
    s_lshl_b32 s39, s3, 11
    s_add_u32 s39, s39, s10
    v_lshlrev_b32 v4, 2, v0
    v_and_b32 v2, 3, v0
    s_mul_i32 s24, s2, 3
    s_add_u32 s24, s24, s3
    s_mul_hi_u32 s25, s24, 89478486
    s_mul_i32 s26, s25, 48
    s_sub_u32 s26, s24, s26
    v_lshrrev_b32 v12, 3, v1
    v_and_b32_e64 v113, 7, v1
    v_mul_u32_u24 v112, 24576, v12
    v_lshl_add_u32 v112, v113, 4, v112
    v_lshlrev_b32_e64 v13, 3, v12
    s_mul_i32 s27, s25, 196608
    s_lshl_b32 s28, s26, 7
    s_add_u32 s27, s27, s28
    s_lshl_b32 s28, s25, 6
    s_lshr_b32 s29, s2, 3
    s_lshl_b32 s29, s29, 2
    s_add_u32 s29, s29, s3
    s_and_b32 s30, s2, 7
    s_lshl_b32 s30, s30, 11
    s_waitcnt lgkmcnt(0)
    s_mov_b64 s[36:37], s[34:35]
    s_cmp_lg_u32 s29, 67
    s_cbranch_scc1 kab_nz
    s_add_u32 s40, s36, 32768
    s_addc_u32 s41, s37, 0
    s_and_b32 s41, s41, 0xffff
    s_mov_b32 s42, 65536
    s_mov_b32 s43, 0x00020000
    buffer_store_dwordx4 v[8:11], v3, s[40:43], s30 offen sc1
    buffer_store_dwordx4 v[8:11], v3, s[40:43], s30 offen offset:1024 sc1
    s_add_u32 s40, s36, 19922944
    s_addc_u32 s41, s37, 0
    s_and_b32 s41, s41, 0xffff
    s_mov_b32 s42, 8192
    s_mov_b32 s43, 0x00020000
    s_lshr_b32 s31, s30, 1
    buffer_store_dwordx4 v[8:11], v3, s[40:43], s31 offen sc1
kab_nz:
    s_mov_b32 s12, s64
    s_nop 0
    s_and_b32 s13, s65, 0xffff
    s_mov_b32 s14, 2097152
    s_mov_b32 s15, 0x00020000
    buffer_load_dwordx4 v[16:19], v3, s[12:15], s39 offen nt
    buffer_load_dwordx4 v[20:23], v3, s[12:15], s39 offen offset:1024 nt
    buffer_load_dword v24, v4, s[12:15], s10 offen offset:0 nt
    buffer_load_dword v25, v4, s[12:15], s10 offen offset:1024 nt
    buffer_load_dword v26, v4, s[12:15], s10 offen offset:2048 nt
    buffer_load_dword v27, v4, s[12:15], s10 offen offset:3072 nt
    buffer_load_dword v28, v4, s[12:15], s38 offen offset:0 nt
    buffer_load_dword v29, v4, s[12:15], s38 offen offset:1024 nt
    buffer_load_dword v30, v4, s[12:15], s38 offen offset:2048 nt
    buffer_load_dword v31, v4, s[12:15], s38 offen offset:3072 nt
    s_mov_b32 s72, s92
    s_and_b32 s73, s93, 0xffff
    s_mov_b32 s74, 1024
    s_mov_b32 s75, 0x00020000
    s_mov_b32 s76, s94
    s_and_b32 s77, s95, 0xffff
    s_mov_b32 s78, 3145728
    s_mov_b32 s79, 0x00020000
    s_cmp_eq_u32 s3, 3
    s_cselect_b32 s74, 0, s74
    s_cselect_b32 s78, 0, s78
    s_nop 0
    buffer_load_dwordx2 v[114:115], v13, s[72:75], s28 offen
    buffer_load_dwordx4 v[128:131], v112, s[76:79], s27 offen nt
    s_add_u32 s27, s27, 6144
    buffer_load_dwordx4 v[132:135], v112, s[76:79], s27 offen nt
    s_add_u32 s27, s27, 6144
    buffer_load_dwordx4 v[136:139], v112, s[76:79], s27 offen nt
    s_add_u32 s27, s27, 6144
    buffer_load_dwordx4 v[140:143], v112, s[76:79], s27 offen nt
    s_barrier
    s_lshr_b32 s5, s2, 4
    s_and_b32 s6, s2, 15
    s_lshl_b32 s6, s6, 1
    s_add_u32 s6, s6, s3
    s_mul_i32 s6, s6, 43
    s_lshr_b32 s6, s6, 3
    s_min_u32 s6, s6, 166
    v_lshrrev_b32 v92, 3, v1
    v_and_b32_e64 v95, 7, v1
    v_mul_u32_u24 v93, 11008, v92
    v_lshl_add_u32 v93, v95, 4, v93
    v_cmp_gt_u32 vcc, 6, v95
    v_mov_b32 v94, 0x7fff0000
    s_nop 0
    v_cndmask_b32 v93, v94, v93, vcc
    s_lshl_b32 s8, s2, 13
    v_add_u32_e64 v94, s8, v3
    s_mul_i32 s8, s5, 88064
    s_lshl_b32 s9, s6, 4
    s_add_u32 s8, s8, s9
    s_cmp_lt_u32 s3, 2
    s_cselect_b64 vcc, -1, 0
    s_cselect_b64 s[68:69], s[80:81], s[86:87]
    s_mov_b32 s70, 704512
    s_cselect_b32 s70, 1409024, s70
    s_cselect_b32 s8, s8, 0
    s_movk_i32 s9, 1024
    s_cselect_b32 s9, 2752, s9
    v_cndmask_b32 v93, v94, v93, vcc
    s_and_b32 s69, s69, 0xffff
    s_mov_b32 s71, 0x00020000
    s_mov_b32 s60, s32
    s_and_b32 s61, s33, 0xffff
    s_mov_b32 s62, 256
    s_mov_b32 s63, 0x00020000
    s_add_u32 s40, s36, 32768
    s_addc_u32 s41, s37, 0
    s_and_b32 s41, s41, 0xffff
    s_mov_b32 s42, 65536
    s_mov_b32 s43, 0x00020000
    s_add_u32 s44, s36, 17825792
    s_addc_u32 s45, s37, 0
    s_and_b32 s45, s45, 0xffff
    s_mov_b32 s46, 2105344
    s_mov_b32 s47, 0x00020000
    s_add_u32 s52, s36, 262144
    s_addc_u32 s53, s37, 0
    s_and_b32 s53, s53, 0xffff
    s_mov_b32 s54, 196608
    s_mov_b32 s55, 0x00020000
    v_and_b32 v84, 7, v1
    v_lshlrev_b32 v84, 5, v84
    s_mov_b32 s48, 0x05040100
    s_mov_b32 s49, 0x07060302
    s_mov_b32 s50, 0x3b000000
    s_mov_b32 s51, 0x3727c5ac
    v_lshrrev_b32 v4, 1, v1
    s_lshl_b32 s15, s3, 6
    v_add_u32 v4, s15, v4
    v_and_b32 v7, 1, v1
    v_lshlrev_b32_e64 v6, 13, v4
    v_lshl_add_u32 v6, v7, 4, v6
    v_mul_u32_u24 v9, 4608, v7
    v_add_u32 v9, 17280, v9
    v_lshl_add_u32 v9, v4, 4, v9
    v_lshlrev_b32 v10, 2, v7
    v_lshlrev_b32 v11, 5, v4
    v_lshl_add_u32 v14, v7, 4, v11
    v_add_u32 v14, 25984, v14
    s_mov_b32 s19, 2097152
    s_lshl_b32 s20, s89, 12
    s_lshr_b32 s21, s4, 1
    s_lshl_b32 s21, s21, 5
    s_add_u32 s20, s20, s21
    s_add_u32 s21, s20, 262144
    s_lshr_b32 s15, s2, 3
    s_and_b32 s15, s15, 15
    s_lshl_b32 s15, s15, 7
    v_lshl_add_u32 v88, v1, 11, s15
    s_and_b32 s15, s2, 7
    s_lshl_b32 s15, s15, 11
    v_and_b32 v89, 15, v1
    v_lshl_add_u32 v89, v89, 7, s15
    v_mov_b32 v86, 8
    v_mov_b32 v90, 28
    v_and_b32 v82, 15, v1
    v_lshrrev_b32 v83, 4, v1
    v_mul_u32_u24 v82, 12288, v82
    v_and_b32_e64 v8, 1, v83
    v_lshl_add_u32 v85, v8, 11, v82
    v_add_u32 v85, 8192, v85
    v_lshl_add_u32 v82, v83, 11, v82
    s_lshl_b32 s58, s88, 2
    v_lshlrev_b32 v5, 4, v0
    v_bfe_u32 v15, v1, 3, 1
    s_lshl_b32 s15, s3, 3
    v_lshl_add_u32 v15, v15, 2, s15
    s_lshl_b32 s14, s2, 5
    s_add_u32 s14, s14, s19
    v_mov_b32 v81, 24
    s_cmp_lg_u32 s29, 67
    s_cbranch_scc1 kab_nr
    s_lshr_b32 s31, s30, 6
    v_mov_b32 v8, 0
    s_waitcnt vmcnt(15)
    s_mov_b64 exec, 1
    buffer_store_dword v248, v8, s[60:63], s31 offen sc1
    s_mov_b64 exec, -1
    v_mov_b32 v116, 0
    v_mov_b32 v117, 0
    v_mov_b32 v118, 0
    v_mov_b32 v119, 0
    s_add_u32 s31, s30, 16384
    buffer_store_dwordx4 v[116:119], v3, s[40:43], s31 offen sc1
    buffer_store_dwordx4 v[116:119], v3, s[40:43], s31 offen offset:1024 sc1
    s_add_u32 s31, s30, 32768
    buffer_store_dwordx4 v[116:119], v3, s[40:43], s31 offen sc1
    buffer_store_dwordx4 v[116:119], v3, s[40:43], s31 offen offset:1024 sc1
    s_add_u32 s31, s30, 49152
    buffer_store_dwordx4 v[116:119], v3, s[40:43], s31 offen sc1
    buffer_store_dwordx4 v[116:119], v3, s[40:43], s31 offen offset:1024 sc1
    s_waitcnt vmcnt(7)
    s_branch kab_nr2
kab_nr:
    s_waitcnt vmcnt(5)
    s_nop 0
kab_nr2:
    v_perm_b32 v68, v25, v24, s48
    v_perm_b32 v76, v25, v24, s49
    v_perm_b32 v69, v27, v26, s48
    v_perm_b32 v77, v27, v26, s49
    v_perm_b32 v70, v29, v28, s48
    v_perm_b32 v78, v29, v28, s49
    v_perm_b32 v71, v31, v30, s48
    v_perm_b32 v79, v31, v30, s49
    buffer_store_dwordx4 v[68:71], v5, s[44:47], s10 offen sc1
    buffer_store_dwordx4 v[76:79], v5, s[44:47], s38 offen sc1
    v_lshlrev_b32 v32, 16, v16
    v_and_b32 v33, s97, v16
    v_lshlrev_b32 v34, 16, v17
    v_and_b32 v35, s97, v17
    v_lshlrev_b32 v36, 16, v18
    v_and_b32 v37, s97, v18
    v_lshlrev_b32 v38, 16, v19
    v_and_b32 v39, s97, v19
    v_lshlrev_b32 v40, 16, v20
    v_and_b32 v41, s97, v20
    v_lshlrev_b32 v42, 16, v21
    v_and_b32 v43, s97, v21
    v_lshlrev_b32 v44, 16, v22
    v_and_b32 v45, s97, v22
    v_lshlrev_b32 v46, 16, v23
    v_and_b32 v47, s97, v23
    v_pk_add_f32 v[48:49], v[32:33], v[34:35]
    v_pk_add_f32 v[50:51], v[36:37], v[38:39]
    v_pk_add_f32 v[52:53], v[40:41], v[42:43]
    v_pk_add_f32 v[54:55], v[44:45], v[46:47]
    v_pk_add_f32 v[48:49], v[48:49], v[50:51]
    v_pk_add_f32 v[52:53], v[52:53], v[54:55]
    v_add_f32 v48, v48, v49
    v_add_f32 v52, v52, v53
    s_nop 0
    v_add_f32_dpp v56, v48, v48 row_ror:8 row_mask:0xf bank_mask:0x3
    s_nop 1
    v_add_f32_dpp v56, v52, v52 row_ror:8 row_mask:0xf bank_mask:0xc
    s_nop 1
    v_add_f32_dpp v56, v56, v56 row_half_mirror row_mask:0xf bank_mask:0xf
    s_nop 1
    v_add_f32_dpp v56, v56, v56 quad_perm:[2,3,0,1] row_mask:0xf bank_mask:0xf
    s_nop 1
    v_add_f32_dpp v56, v56, v56 quad_perm:[1,0,3,2] row_mask:0xf bank_mask:0xf
    v_mov_b32 v57, v56
    s_nop 1
    v_permlane16_swap_b32 v57, v56
    v_add_f32 v56, v56, v57
    v_mov_b32 v57, v56
    s_nop 1
    v_permlane32_swap_b32 v57, v56
    v_add_f32 v56, v56, v57
    v_mul_f32 v56, s50, v56
    s_nop 0
    v_readlane_b32 s16, v56, 0
    v_readlane_b32 s18, v56, 8
    s_nop 0
    v_pk_add_f32 v[32:33], v[32:33], s[16:17] op_sel_hi:[1,0] neg_lo:[0,1] neg_hi:[0,1]
    v_pk_add_f32 v[34:35], v[34:35], s[16:17] op_sel_hi:[1,0] neg_lo:[0,1] neg_hi:[0,1]
    v_pk_add_f32 v[36:37], v[36:37], s[16:17] op_sel_hi:[1,0] neg_lo:[0,1] neg_hi:[0,1]
    v_pk_add_f32 v[38:39], v[38:39], s[16:17] op_sel_hi:[1,0] neg_lo:[0,1] neg_hi:[0,1]
    v_pk_add_f32 v[40:41], v[40:41], s[18:19] op_sel_hi:[1,0] neg_lo:[0,1] neg_hi:[0,1]
    v_pk_add_f32 v[42:43], v[42:43], s[18:19] op_sel_hi:[1,0] neg_lo:[0,1] neg_hi:[0,1]
    v_pk_add_f32 v[44:45], v[44:45], s[18:19] op_sel_hi:[1,0] neg_lo:[0,1] neg_hi:[0,1]
    v_pk_add_f32 v[46:47], v[46:47], s[18:19] op_sel_hi:[1,0] neg_lo:[0,1] neg_hi:[0,1]
    v_pk_mul_f32 v[48:49], v[32:33], v[32:33]
    v_pk_mul_f32 v[52:53], v[40:41], v[40:41]
    v_pk_fma_f32 v[48:49], v[34:35], v[34:35], v[48:49]
    v_pk_fma_f32 v[52:53], v[42:43], v[42:43], v[52:53]
    v_pk_fma_f32 v[48:49], v[36:37], v[36:37], v[48:49]
    v_pk_fma_f32 v[52:53], v[44:45], v[44:45], v[52:53]
    v_pk_fma_f32 v[48:49], v[38:39], v[38:39], v[48:49]
    v_pk_fma_f32 v[52:53], v[46:47], v[46:47], v[52:53]
    v_add_f32 v48, v48, v49
    v_add_f32 v52, v52, v53
    s_nop 0
    v_add_f32_dpp v58, v48, v48 row_ror:8 row_mask:0xf bank_mask:0x3
    s_nop 1
    v_add_f32_dpp v58, v52, v52 row_ror:8 row_mask:0xf bank_mask:0xc
    s_nop 1
    v_add_f32_dpp v58, v58, v58 row_half_mirror row_mask:0xf bank_mask:0xf
    s_nop 1
    v_add_f32_dpp v58, v58, v58 quad_perm:[2,3,0,1] row_mask:0xf bank_mask:0xf
    s_nop 1
    v_add_f32_dpp v58, v58, v58 quad_perm:[1,0,3,2] row_mask:0xf bank_mask:0xf
    v_mov_b32 v57, v58
    s_nop 1
    v_permlane16_swap_b32 v57, v58
    v_add_f32 v58, v58, v57
    v_mov_b32 v57, v58
    s_nop 1
    v_permlane32_swap_b32 v57, v58
    v_add_f32 v58, v58, v57
    v_mul_f32 v58, s50, v58
    v_cvt_pk_bf16_f32 v58, v58, v58
    v_and_b32 v58, s97, v58
    v_add_f32 v58, s51, v58
    v_cvt_pk_bf16_f32 v58, v58, v58
    v_and_b32 v58, s97, v58
    v_sqrt_f32 v58, v58
    s_nop 0
    v_cvt_pk_bf16_f32 v58, v56, v58
    ds_write_b32 v15, v58 offset:96
    s_waitcnt lgkmcnt(0)
    s_mov_b64 exec, 1
    ds_add_u32 v81, v248
    s_mov_b64 exec, -1
    s_cmp_eq_u32 s3, 3
    s_cbranch_scc1 kab_sync
    s_mov_b32 s31, 0xbfb8aa3b
    s_waitcnt vmcnt(6)
    v_lshlrev_b32 v44, 16, v114
    v_and_b32 v45, s97, v114
    v_lshlrev_b32 v46, 16, v115
    v_and_b32 v47, s97, v115
    v_mul_f32 v48, s31, v44
    v_mul_f32 v49, s31, v45
    v_mul_f32 v50, s31, v46
    v_mul_f32 v51, s31, v47
    v_exp_f32 v48, v48
    v_exp_f32 v49, v49
    v_exp_f32 v50, v50
    v_exp_f32 v51, v51
    v_add_f32 v48, 1.0, v48
    v_add_f32 v49, 1.0, v49
    v_add_f32 v50, 1.0, v50
    v_add_f32 v51, 1.0, v51
    v_rcp_f32 v48, v48
    v_rcp_f32 v49, v49
    v_rcp_f32 v50, v50
    v_rcp_f32 v51, v51
    v_mul_f32 v48, v44, v48
    v_mul_f32 v49, v45, v49
    v_mul_f32 v50, v46, v50
    v_mul_f32_e64 v51, v47, v51
    v_cvt_pk_bf16_f32 v114, v48, v49
    v_cvt_pk_bf16_f32 v115, v50, v51
    v_lshlrev_b32 v44, 16, v114
    v_and_b32 v46, s97, v114
    v_lshlrev_b32 v48, 16, v115
    v_and_b32 v50, s97, v115
    s_waitcnt vmcnt(5)
    v_lshlrev_b32 v60, 16, v128
    v_and_b32 v61, s97, v128
    v_lshlrev_b32 v62, 16, v129
    v_and_b32 v63, s97, v129
    v_lshlrev_b32 v64, 16, v130
    v_and_b32 v65, s97, v130
    v_lshlrev_b32 v66, 16, v131
    v_and_b32_e64 v67, s97, v131
    v_pk_mul_f32 v[52:53], v[60:61], v[44:45] op_sel_hi:[1,0]
    v_pk_mul_f32 v[54:55], v[62:63], v[44:45] op_sel_hi:[1,0]
    v_pk_mul_f32 v[56:57], v[64:65], v[44:45] op_sel_hi:[1,0]
    v_pk_mul_f32 v[58:59], v[66:67], v[44:45] op_sel_hi:[1,0]
    s_waitcnt vmcnt(4)
    v_lshlrev_b32 v60, 16, v132
    v_and_b32 v61, s97, v132
    v_lshlrev_b32 v62, 16, v133
    v_and_b32 v63, s97, v133
    v_lshlrev_b32 v64, 16, v134
    v_and_b32 v65, s97, v134
    v_lshlrev_b32 v66, 16, v135
    v_and_b32_e64 v67, s97, v135
    v_pk_fma_f32 v[52:53], v[60:61], v[46:47], v[52:53] op_sel:[0,0,0] op_sel_hi:[1,0,1]
    v_pk_fma_f32 v[54:55], v[62:63], v[46:47], v[54:55] op_sel:[0,0,0] op_sel_hi:[1,0,1]
    v_pk_fma_f32 v[56:57], v[64:65], v[46:47], v[56:57] op_sel:[0,0,0] op_sel_hi:[1,0,1]
    v_pk_fma_f32 v[58:59], v[66:67], v[46:47], v[58:59] op_sel:[0,0,0] op_sel_hi:[1,0,1]
    s_waitcnt vmcnt(3)
    v_lshlrev_b32 v60, 16, v136
    v_and_b32 v61, s97, v136
    v_lshlrev_b32 v62, 16, v137
    v_and_b32 v63, s97, v137
    v_lshlrev_b32 v64, 16, v138
    v_and_b32 v65, s97, v138
    v_lshlrev_b32 v66, 16, v139
    v_and_b32_e64 v67, s97, v139
    v_pk_fma_f32 v[52:53], v[60:61], v[48:49], v[52:53] op_sel:[0,0,0] op_sel_hi:[1,0,1]
    v_pk_fma_f32 v[54:55], v[62:63], v[48:49], v[54:55] op_sel:[0,0,0] op_sel_hi:[1,0,1]
    v_pk_fma_f32 v[56:57], v[64:65], v[48:49], v[56:57] op_sel:[0,0,0] op_sel_hi:[1,0,1]
    v_pk_fma_f32 v[58:59], v[66:67], v[48:49], v[58:59] op_sel:[0,0,0] op_sel_hi:[1,0,1]
    s_waitcnt vmcnt(2)
    v_lshlrev_b32 v60, 16, v140
    v_and_b32 v61, s97, v140
    v_lshlrev_b32 v62, 16, v141
    v_and_b32 v63, s97, v141
    v_lshlrev_b32 v64, 16, v142
    v_and_b32 v65, s97, v142
    v_lshlrev_b32 v66, 16, v143
    v_and_b32_e64 v67, s97, v143
    v_pk_fma_f32 v[52:53], v[60:61], v[50:51], v[52:53] op_sel:[0,0,0] op_sel_hi:[1,0,1]
    v_pk_fma_f32 v[54:55], v[62:63], v[50:51], v[54:55] op_sel:[0,0,0] op_sel_hi:[1,0,1]
    v_pk_fma_f32 v[56:57], v[64:65], v[50:51], v[56:57] op_sel:[0,0,0] op_sel_hi:[1,0,1]
    v_pk_fma_f32 v[58:59], v[66:67], v[50:51], v[58:59] op_sel:[0,0,0] op_sel_hi:[1,0,1]
    v_add_f32_dpp v60, v52, v52 row_ror:8 row_mask:0xf bank_mask:0x3
    s_nop 1
    v_add_f32_dpp v60, v56, v56 row_ror:8 row_mask:0xf bank_mask:0xc
    v_add_f32_dpp v61, v53, v53 row_ror:8 row_mask:0xf bank_mask:0x3
    s_nop 1
    v_add_f32_dpp v61, v57, v57 row_ror:8 row_mask:0xf bank_mask:0xc
    v_add_f32_dpp v62, v54, v54 row_ror:8 row_mask:0xf bank_mask:0x3
    s_nop 1
    v_add_f32_dpp v62, v58, v58 row_ror:8 row_mask:0xf bank_mask:0xc
    v_add_f32_dpp v63, v55, v55 row_ror:8 row_mask:0xf bank_mask:0x3
    s_nop 1
    v_add_f32_dpp v63, v59, v59 row_ror:8 row_mask:0xf bank_mask:0xc
    v_bfe_u32 v64, v1, 3, 1
    v_lshlrev_b32_e64 v65, 5, v113
    v_lshl_add_u32 v65, v64, 4, v65
    v_permlane16_swap_b32 v60, v61
    v_permlane16_swap_b32 v62, v63
    v_bfe_u32 v64, v1, 5, 1
    v_lshl_add_u32 v65, v64, 3, v65
    v_add_f32 v60, v60, v61
    v_add_f32 v62, v62, v63
    v_bfe_u32 v64, v1, 4, 1
    v_lshl_add_u32 v65, v64, 2, v65
    v_permlane32_swap_b32 v60, v62
    s_mul_i32 s56, s25, 12288
    s_lshl_b32 s57, s26, 8
    s_add_u32 s56, s56, s57
    v_add_f32 v60, v60, v62
    buffer_store_dword v60, v65, s[52:55], s56 offen sc1
    s_waitcnt vmcnt(0)
    s_waitcnt lgkmcnt(0)
    s_mov_b64 exec, 1
    ds_add_u32 v86, v248
    s_mov_b64 exec, -1
kab_gs:
    s_sleep 1
    ds_read_b32 v87, v90
    s_waitcnt lgkmcnt(0)
    v_readfirstlane_b32 s90, v87
    s_nop 1
    s_cmp_eq_u32 s90, 0
    s_cbranch_scc1 kab_gs
    s_branch kab_go
kab_sync:
    s_mov_b32 s56, 0
adaLN_cond__ssm_conv_s4d__mixer_gmlp__prompt_kernel_w6:
    ds_read_b32 v87, v81
    s_waitcnt lgkmcnt(0)
    v_readfirstlane_b32 s90, v87
    s_nop 1
    s_cmp_lt_u32 s90, 4
    s_cbranch_scc1 adaLN_cond__ssm_conv_s4d__mixer_gmlp__prompt_kernel_w6
    v_and_b32 v15, 1, v1
    v_lshlrev_b32_e64 v15, 4, v15
    ds_read_b128 v[60:63], v15 offset:96
kab_rp:
    buffer_load_dword v91, v84, s[60:63], 0 offen sc1
    s_add_u32 s56, s56, 1
    s_waitcnt vmcnt(0) lgkmcnt(0)
    v_cmp_eq_u32 vcc, 0, v91
    s_nop 4
    s_cbranch_vccz kab_rg
    s_sleep 4
    s_cmp_lt_u32 s56, 1048576
    s_cbranch_scc1 kab_rp
kab_rg:
    s_mov_b64 exec, 3
    buffer_store_dwordx4 v[60:63], v15, s[44:47], s14 offen sc1
    s_mov_b64 exec, -1
adaLN_cond__ssm_conv_s4d__mixer_gmlp__prompt_kernel_w7:
    ds_read_b32 v87, v86
    s_waitcnt lgkmcnt(0)
    v_readfirstlane_b32 s90, v87
    s_nop 1
    s_cmp_lt_u32 s90, 3
    s_cbranch_scc1 adaLN_cond__ssm_conv_s4d__mixer_gmlp__prompt_kernel_w7
    s_mov_b64 exec, 0xff
    buffer_atomic_add v248, v88, s[40:43], 0 offen sc1
    s_mov_b64 exec, -1
    s_sleep 16
    s_mov_b32 s56, 0
    s_mov_b32 s91, 0
kab_b1:
    s_sleep 4
    buffer_load_dword v87, v89, s[40:43], s91 offen sc1
    s_add_u32 s56, s56, 1
    s_waitcnt vmcnt(0)
    v_cmp_gt_u32 vcc, 16, v87
    s_nop 4
    s_cbranch_vccz kab_b1_ok
    s_cmp_lt_u32 s56, 1048576
    s_cbranch_scc1 kab_b1
kab_b1_ok:
    s_mov_b64 exec, 1
    ds_write_b32 v90, v248
    s_mov_b64 exec, -1
    s_nop 0
    buffer_load_dword v56, v82, s[52:55], s58 offen sc1
    buffer_load_dword v57, v82, s[52:55], s58 offen offset:8 sc1
kab_go:
    buffer_load_dwordx4 v[16:19], v6, s[44:47], s20 offen sc1
    buffer_load_dwordx4 v[20:23], v6, s[44:47], s21 offen sc1
    buffer_load_dwordx4 v[128:131], v11, s[44:47], s19 offen offset:0 sc1
    buffer_load_dwordx4 v[132:135], v11, s[44:47], s19 offen offset:16 sc1
    buffer_load_dwordx4 v[136:139], v11, s[44:47], s19 offen offset:1024 sc1
    buffer_load_dwordx4 v[140:143], v11, s[44:47], s19 offen offset:1040 sc1
    v_mov_b32 v86, 32
    s_cmp_lg_u32 s3, 3
    s_cbranch_scc1 kab_p0
    s_waitcnt vmcnt(6)
    v_add_f32_dpp v56, v56, v56 row_ror:8 row_mask:0xf bank_mask:0xf
    v_add_f32_dpp v57, v57, v57 row_ror:8 row_mask:0xf bank_mask:0xf
    s_nop 0
    v_add_f32_dpp v56, v56, v56 row_ror:4 row_mask:0xf bank_mask:0xf
    v_add_f32_dpp v57, v57, v57 row_ror:4 row_mask:0xf bank_mask:0xf
    s_nop 0
    v_add_f32_dpp v56, v56, v56 row_ror:2 row_mask:0xf bank_mask:0xf
    v_add_f32_dpp v57, v57, v57 row_ror:2 row_mask:0xf bank_mask:0xf
    s_nop 0
    v_add_f32_dpp v56, v56, v56 row_ror:1 row_mask:0xf bank_mask:0xf
    v_add_f32_dpp v57, v57, v57 row_ror:1 row_mask:0xf bank_mask:0xf
    v_cvt_pk_bf16_f32 v56, v56, v56
    v_and_b32 v56, s97, v56
    v_cvt_pk_bf16_f32 v57, v57, v57
    v_and_b32 v57, s97, v57
    v_lshlrev_b32 v66, 3, v83
    s_mov_b32 exec_lo, 0x00010001
    s_mov_b32 exec_hi, 0x00010001
    ds_write_b64 v66, v[56:57] offset:64
    s_mov_b64 exec, -1
    s_waitcnt lgkmcnt(0)
    s_mov_b64 exec, 1
    ds_add_u32 v86, v248
    s_mov_b64 exec, -1
    s_lshr_b32 s22, s2, 3
    s_and_b32 s22, s22, 3
    s_and_b32 s23, s2, 1
    s_lshl_b32 s23, s23, 2
    s_add_u32 s22, s22, s23
    s_lshl_b32 s22, s22, 8
    s_add_u32 s22, s22, 10240
    v_and_b32_e64 v8, 15, v1
    v_mul_u32_u24 v8, 12288, v8
    v_lshl_add_u32 v8, v83, 4, v8
    buffer_load_dwordx4 v[176:179], v8, s[52:55], s22 offen offset:0 sc1
    buffer_load_dwordx4 v[180:183], v8, s[52:55], s22 offen offset:64 sc1
    buffer_load_dwordx4 v[184:187], v8, s[52:55], s22 offen offset:128 sc1
    buffer_load_dwordx4 v[188:191], v8, s[52:55], s22 offen offset:192 sc1
    s_waitcnt vmcnt(4)
    s_branch kab_pw
kab_p0:
    buffer_load_dwordx4 v[96:99], v93, s[68:71], s8 offen nt
    s_add_u32 s8, s8, s9
    buffer_load_dwordx4 v[100:103], v93, s[68:71], s8 offen nt
    s_add_u32 s8, s8, s9
    buffer_load_dwordx4 v[104:107], v93, s[68:71], s8 offen nt
    s_add_u32 s8, s8, s9
    buffer_load_dwordx4 v[108:111], v93, s[68:71], s8 offen nt
    s_add_u32 s8, s8, s9
    s_cmp_eq_u32 s3, 2
    s_cbranch_scc1 kab_p2
    v_mul_u32_u24 v8, 12288, v95
    v_lshl_add_u32 v8, v92, 4, v8
    s_lshl_b32 s22, s5, 7
    s_add_u32 s22, s22, 6144
    s_add_u32 s23, s22, 98304
    buffer_load_dwordx4 v[176:179], v8, s[52:55], s22 offen sc1
    buffer_load_dwordx4 v[180:183], v8, s[52:55], s22 offen offset:2048 sc1
    buffer_load_dwordx4 v[184:187], v8, s[52:55], s23 offen sc1
    buffer_load_dwordx4 v[188:191], v8, s[52:55], s23 offen offset:2048 sc1
    s_branch kab_p3
kab_p2:
    buffer_load_dwordx4 v[112:115], v93, s[68:71], s8 offen nt
    s_add_u32 s8, s8, s9
    buffer_load_dwordx4 v[116:119], v93, s[68:71], s8 offen nt
    s_add_u32 s8, s8, s9
    buffer_load_dwordx4 v[120:123], v93, s[68:71], s8 offen nt
    s_add_u32 s8, s8, s9
    buffer_load_dwordx4 v[124:127], v93, s[68:71], s8 offen nt
    s_add_u32 s8, s8, s9
kab_p3:
    s_waitcnt vmcnt(8)
kab_pw:
    s_mov_b32 s56, 0
kab_sc:
    v_min3_u32 v24, v128, v129, v130
    v_min3_u32 v24, v24, v131, v132
    v_min3_u32 v24, v24, v133, v134
    v_min3_u32 v24, v24, v135, v136
    v_min3_u32 v24, v24, v137, v138
    v_min3_u32 v24, v24, v139, v140
    v_min3_u32 v24, v24, v141, v142
    v_min_u32 v24, v24, v143
    v_cmp_eq_u32 vcc, 0, v24
    s_nop 4
    s_cbranch_vccz kab_so
    buffer_load_dwordx4 v[128:131], v11, s[44:47], s19 offen offset:0 sc1
    buffer_load_dwordx4 v[132:135], v11, s[44:47], s19 offen offset:16 sc1
    buffer_load_dwordx4 v[136:139], v11, s[44:47], s19 offen offset:1024 sc1
    buffer_load_dwordx4 v[140:143], v11, s[44:47], s19 offen offset:1040 sc1
    s_add_u32 s56, s56, 1
    s_waitcnt vmcnt(0)
    s_cmp_lt_u32 s56, 1048576
    s_cbranch_scc1 kab_sc
kab_so:
    ds_write_b128 v14, v[16:19] offset:0
    ds_write_b128 v14, v[20:23] offset:1024
    v_lshlrev_b32 v144, 16, v128
    v_and_b32 v160, s97, v128
    v_lshlrev_b32 v145, 16, v129
    v_and_b32 v161, s97, v129
    v_lshlrev_b32 v146, 16, v130
    v_and_b32 v162, s97, v130
    v_lshlrev_b32 v147, 16, v131
    v_and_b32 v163, s97, v131
    v_lshlrev_b32 v148, 16, v132
    v_and_b32 v164, s97, v132
    v_lshlrev_b32 v149, 16, v133
    v_and_b32 v165, s97, v133
    v_lshlrev_b32 v150, 16, v134
    v_and_b32 v166, s97, v134
    v_lshlrev_b32 v151, 16, v135
    v_and_b32 v167, s97, v135
    v_lshlrev_b32 v152, 16, v136
    v_and_b32 v168, s97, v136
    v_lshlrev_b32 v153, 16, v137
    v_and_b32 v169, s97, v137
    v_lshlrev_b32 v154, 16, v138
    v_and_b32 v170, s97, v138
    v_lshlrev_b32 v155, 16, v139
    v_and_b32 v171, s97, v139
    v_lshlrev_b32 v156, 16, v140
    v_and_b32 v172, s97, v140
    v_lshlrev_b32 v157, 16, v141
    v_and_b32 v173, s97, v141
    v_lshlrev_b32 v158, 16, v142
    v_and_b32 v174, s97, v142
    v_lshlrev_b32 v159, 16, v143
    v_and_b32 v175, s97, v143
    v_rcp_f32 v160, v160
    v_rcp_f32 v161, v161
    v_rcp_f32 v162, v162
    v_rcp_f32 v163, v163
    v_rcp_f32 v164, v164
    v_rcp_f32 v165, v165
    v_rcp_f32 v166, v166
    v_rcp_f32 v167, v167
    v_rcp_f32 v168, v168
    v_rcp_f32 v169, v169
    v_rcp_f32 v170, v170
    v_rcp_f32 v171, v171
    v_rcp_f32 v172, v172
    v_rcp_f32 v173, v173
    v_rcp_f32 v174, v174
    v_rcp_f32 v175, v175
    v_lshlrev_b32 v32, 16, v16
    v_and_b32 v33, s97, v16
    v_lshlrev_b32 v34, 16, v17
    v_and_b32 v35, s97, v17
    v_lshlrev_b32 v36, 16, v18
    v_and_b32 v37, s97, v18
    v_lshlrev_b32 v38, 16, v19
    v_and_b32 v39, s97, v19
    v_lshlrev_b32 v40, 16, v20
    v_and_b32 v41, s97, v20
    v_lshlrev_b32 v42, 16, v21
    v_and_b32 v43, s97, v21
    v_lshlrev_b32 v44, 16, v22
    v_and_b32 v45, s97, v22
    v_lshlrev_b32 v46, 16, v23
    v_and_b32_e64 v47, s97, v23
    v_pk_add_f32 v[32:33], v[32:33], v[144:145] neg_lo:[0,1] neg_hi:[0,1]
    v_pk_add_f32 v[34:35], v[34:35], v[146:147] neg_lo:[0,1] neg_hi:[0,1]
    v_pk_add_f32 v[36:37], v[36:37], v[148:149] neg_lo:[0,1] neg_hi:[0,1]
    v_pk_add_f32 v[38:39], v[38:39], v[150:151] neg_lo:[0,1] neg_hi:[0,1]
    v_pk_add_f32 v[40:41], v[40:41], v[152:153] neg_lo:[0,1] neg_hi:[0,1]
    v_pk_add_f32 v[42:43], v[42:43], v[154:155] neg_lo:[0,1] neg_hi:[0,1]
    v_pk_add_f32 v[44:45], v[44:45], v[156:157] neg_lo:[0,1] neg_hi:[0,1]
    v_pk_add_f32 v[46:47], v[46:47], v[158:159] neg_lo:[0,1] neg_hi:[0,1]
    v_cvt_pk_bf16_f32 v16, v32, v33
    v_cvt_pk_bf16_f32 v17, v34, v35
    v_cvt_pk_bf16_f32 v18, v36, v37
    v_cvt_pk_bf16_f32 v19, v38, v39
    v_cvt_pk_bf16_f32 v20, v40, v41
    v_cvt_pk_bf16_f32 v21, v42, v43
    v_cvt_pk_bf16_f32 v22, v44, v45
    v_cvt_pk_bf16_f32 v23, v46, v47
    v_lshlrev_b32 v32, 16, v16
    v_and_b32 v33, s97, v16
    v_lshlrev_b32 v34, 16, v17
    v_and_b32 v35, s97, v17
    v_lshlrev_b32 v36, 16, v18
    v_and_b32 v37, s97, v18
    v_lshlrev_b32 v38, 16, v19
    v_and_b32 v39, s97, v19
    v_lshlrev_b32 v40, 16, v20
    v_and_b32 v41, s97, v20
    v_lshlrev_b32 v42, 16, v21
    v_and_b32 v43, s97, v21
    v_lshlrev_b32 v44, 16, v22
    v_and_b32 v45, s97, v22
    v_lshlrev_b32 v46, 16, v23
    v_and_b32 v47, s97, v23
    v_pk_mul_f32 v[32:33], v[32:33], v[160:161]
    v_pk_mul_f32 v[34:35], v[34:35], v[162:163]
    v_pk_mul_f32 v[36:37], v[36:37], v[164:165]
    v_pk_mul_f32 v[38:39], v[38:39], v[166:167]
    v_pk_mul_f32 v[40:41], v[40:41], v[168:169]
    v_pk_mul_f32 v[42:43], v[42:43], v[170:171]
    v_pk_mul_f32 v[44:45], v[44:45], v[172:173]
    v_pk_mul_f32 v[46:47], v[46:47], v[174:175]
    v_cvt_pk_bf16_f32 v16, v32, v33
    v_cvt_pk_bf16_f32 v17, v34, v35
    v_cvt_pk_bf16_f32 v18, v36, v37
    v_cvt_pk_bf16_f32 v19, v38, v39
    v_cvt_pk_bf16_f32 v20, v40, v41
    v_cvt_pk_bf16_f32 v21, v42, v43
    v_cvt_pk_bf16_f32 v22, v44, v45
    v_cvt_pk_bf16_f32 v23, v46, v47
adaLN_cond__ssm_conv_s4d__mixer_gmlp__prompt_kernel_w8:
    ds_read_b32 v87, v86
    s_waitcnt lgkmcnt(0)
    v_readfirstlane_b32 s90, v87
    s_nop 1
    s_cmp_lt_u32 s90, 1
    s_cbranch_scc1 adaLN_cond__ssm_conv_s4d__mixer_gmlp__prompt_kernel_w8
    ds_read_b32 v26, v10 offset:64
    ds_read_b32 v12, v10 offset:72
    v_lshlrev_b32 v32, 16, v16
    v_and_b32 v33, s97, v16
    v_lshlrev_b32 v34, 16, v17
    v_and_b32 v35, s97, v17
    v_lshlrev_b32 v36, 16, v18
    v_and_b32 v37, s97, v18
    v_lshlrev_b32 v38, 16, v19
    v_and_b32 v39, s97, v19
    v_lshlrev_b32 v40, 16, v20
    v_and_b32 v41, s97, v20
    v_lshlrev_b32 v42, 16, v21
    v_and_b32 v43, s97, v21
    v_lshlrev_b32 v44, 16, v22
    v_and_b32 v45, s97, v22
    v_lshlrev_b32 v46, 16, v23
    v_and_b32 v47, s97, v23
    s_waitcnt lgkmcnt(0)
    v_add_f32_e64 v12, 1.0, v12
    v_cvt_pk_bf16_f32 v12, v12, v12
    v_and_b32_e64 v12, s97, v12
    v_pk_mul_f32 v[32:33], v[32:33], v[12:13] op_sel:[0,0] op_sel_hi:[1,0]
    v_pk_mul_f32 v[34:35], v[34:35], v[12:13] op_sel:[0,0] op_sel_hi:[1,0]
    v_pk_mul_f32 v[36:37], v[36:37], v[12:13] op_sel:[0,0] op_sel_hi:[1,0]
    v_pk_mul_f32 v[38:39], v[38:39], v[12:13] op_sel:[0,0] op_sel_hi:[1,0]
    v_pk_mul_f32 v[40:41], v[40:41], v[12:13] op_sel:[0,0] op_sel_hi:[1,0]
    v_pk_mul_f32 v[42:43], v[42:43], v[12:13] op_sel:[0,0] op_sel_hi:[1,0]
    v_pk_mul_f32 v[44:45], v[44:45], v[12:13] op_sel:[0,0] op_sel_hi:[1,0]
    v_pk_mul_f32 v[46:47], v[46:47], v[12:13] op_sel:[0,0] op_sel_hi:[1,0]
    v_cvt_pk_bf16_f32 v16, v32, v33
    v_cvt_pk_bf16_f32 v17, v34, v35
    v_cvt_pk_bf16_f32 v18, v36, v37
    v_cvt_pk_bf16_f32 v19, v38, v39
    v_cvt_pk_bf16_f32 v20, v40, v41
    v_cvt_pk_bf16_f32 v21, v42, v43
    v_cvt_pk_bf16_f32 v22, v44, v45
    v_cvt_pk_bf16_f32 v23, v46, v47
    v_lshlrev_b32 v32, 16, v16
    v_and_b32 v33, s97, v16
    v_lshlrev_b32 v34, 16, v17
    v_and_b32 v35, s97, v17
    v_lshlrev_b32 v36, 16, v18
    v_and_b32 v37, s97, v18
    v_lshlrev_b32 v38, 16, v19
    v_and_b32 v39, s97, v19
    v_lshlrev_b32 v40, 16, v20
    v_and_b32 v41, s97, v20
    v_lshlrev_b32 v42, 16, v21
    v_and_b32 v43, s97, v21
    v_lshlrev_b32 v44, 16, v22
    v_and_b32 v45, s97, v22
    v_lshlrev_b32 v46, 16, v23
    v_and_b32 v47, s97, v23
    v_pk_add_f32 v[32:33], v[32:33], v[26:27] op_sel_hi:[1,0]
    v_pk_add_f32 v[34:35], v[34:35], v[26:27] op_sel_hi:[1,0]
    v_pk_add_f32 v[36:37], v[36:37], v[26:27] op_sel_hi:[1,0]
    v_pk_add_f32 v[38:39], v[38:39], v[26:27] op_sel_hi:[1,0]
    v_pk_add_f32 v[40:41], v[40:41], v[26:27] op_sel_hi:[1,0]
    v_pk_add_f32 v[42:43], v[42:43], v[26:27] op_sel_hi:[1,0]
    v_pk_add_f32 v[44:45], v[44:45], v[26:27] op_sel_hi:[1,0]
    v_pk_add_f32 v[46:47], v[46:47], v[26:27] op_sel_hi:[1,0]
    v_cvt_pk_bf16_f32 v16, v32, v33
    v_cvt_pk_bf16_f32 v17, v34, v35
    v_cvt_pk_bf16_f32 v18, v36, v37
    v_cvt_pk_bf16_f32 v19, v38, v39
    v_cvt_pk_bf16_f32 v20, v40, v41
    v_cvt_pk_bf16_f32 v21, v42, v43
    v_cvt_pk_bf16_f32 v22, v44, v45
    v_cvt_pk_bf16_f32 v23, v46, v47
    ds_write_b128 v9, v[16:19] offset:0
    ds_write_b128 v9, v[20:23] offset:512
    s_waitcnt lgkmcnt(0)
    s_barrier
    s_setprio 0
    s_cmp_lt_u32 s3, 2
    s_cbranch_scc1 kab_wpj
    s_cmp_eq_u32 s3, 2
    s_cbranch_scc1 kab_woj
    v_mov_b32 v8, -1
    v_mov_b32 v9, -1
    v_lshlrev_b32 v7, 3, v1
    s_lshl_b32 s58, s2, 9
    s_add_u32 s52, s36, 131072
    s_addc_u32 s53, s37, 0
    s_and_b32 s53, s53, 0xffff
    s_mov_b32 s54, 131072
    s_mov_b32 s55, 0x00020000
    buffer_store_dwordx2 v[8:9], v7, s[52:55], s58 offen sc1
    s_mov_b32 s28, s82
    s_and_b32 s29, s83, 0xffff
    s_mov_b32 s30, 8388608
    s_mov_b32 s31, 0x00020000
    s_lshl_b32 s22, s4, 15
    v_lshrrev_b32 v8, 3, v1
    v_lshlrev_b32 v8, 12, v8
    v_and_b32_e64 v9, 7, v1
    v_lshl_add_u32 v8, v9, 4, v8
    buffer_load_dwordx4 v[244:247], v8, s[28:31], s22 offen offset:0
    buffer_load_dwordx4 v[244:247], v8, s[28:31], s22 offen offset:128
    buffer_load_dwordx4 v[244:247], v8, s[28:31], s22 offen offset:256
    buffer_load_dwordx4 v[244:247], v8, s[28:31], s22 offen offset:384
    buffer_load_dwordx4 v[244:247], v8, s[28:31], s22 offen offset:512
    buffer_load_dwordx4 v[244:247], v8, s[28:31], s22 offen offset:640
    buffer_load_dwordx4 v[244:247], v8, s[28:31], s22 offen offset:768
    buffer_load_dwordx4 v[244:247], v8, s[28:31], s22 offen offset:896
    buffer_load_dwordx4 v[244:247], v8, s[28:31], s22 offen offset:1024
    buffer_load_dwordx4 v[244:247], v8, s[28:31], s22 offen offset:1152
    buffer_load_dwordx4 v[244:247], v8, s[28:31], s22 offen offset:1280
    buffer_load_dwordx4 v[244:247], v8, s[28:31], s22 offen offset:1408
    buffer_load_dwordx4 v[244:247], v8, s[28:31], s22 offen offset:1536
    buffer_load_dwordx4 v[244:247], v8, s[28:31], s22 offen offset:1664
    buffer_load_dwordx4 v[244:247], v8, s[28:31], s22 offen offset:1792
    buffer_load_dwordx4 v[244:247], v8, s[28:31], s22 offen offset:1920
    buffer_load_dwordx4 v[244:247], v8, s[28:31], s22 offen offset:2048
    buffer_load_dwordx4 v[244:247], v8, s[28:31], s22 offen offset:2176
    buffer_load_dwordx4 v[244:247], v8, s[28:31], s22 offen offset:2304
    buffer_load_dwordx4 v[244:247], v8, s[28:31], s22 offen offset:2432
    buffer_load_dwordx4 v[244:247], v8, s[28:31], s22 offen offset:2560
    buffer_load_dwordx4 v[244:247], v8, s[28:31], s22 offen offset:2688
    buffer_load_dwordx4 v[244:247], v8, s[28:31], s22 offen offset:2816
    buffer_load_dwordx4 v[244:247], v8, s[28:31], s22 offen offset:2944
    buffer_load_dwordx4 v[244:247], v8, s[28:31], s22 offen offset:3072
    buffer_load_dwordx4 v[244:247], v8, s[28:31], s22 offen offset:3200
    buffer_load_dwordx4 v[244:247], v8, s[28:31], s22 offen offset:3328
    buffer_load_dwordx4 v[244:247], v8, s[28:31], s22 offen offset:3456
    buffer_load_dwordx4 v[244:247], v8, s[28:31], s22 offen offset:3584
    buffer_load_dwordx4 v[244:247], v8, s[28:31], s22 offen offset:3712
    buffer_load_dwordx4 v[244:247], v8, s[28:31], s22 offen offset:3840
    buffer_load_dwordx4 v[244:247], v8, s[28:31], s22 offen offset:3968
    s_waitcnt vmcnt(32)
    s_nop 0
    v_add_f32_dpp v176, v176, v176 row_ror:8 row_mask:0xf bank_mask:0xf
    v_add_f32_dpp v177, v177, v177 row_ror:8 row_mask:0xf bank_mask:0xf
    v_add_f32_dpp v178, v178, v178 row_ror:8 row_mask:0xf bank_mask:0xf
    v_add_f32_dpp v179, v179, v179 row_ror:8 row_mask:0xf bank_mask:0xf
    v_add_f32_dpp v180, v180, v180 row_ror:8 row_mask:0xf bank_mask:0xf
    v_add_f32_dpp v181, v181, v181 row_ror:8 row_mask:0xf bank_mask:0xf
    v_add_f32_dpp v182, v182, v182 row_ror:8 row_mask:0xf bank_mask:0xf
    v_add_f32_dpp v183, v183, v183 row_ror:8 row_mask:0xf bank_mask:0xf
    v_add_f32_dpp v184, v184, v184 row_ror:8 row_mask:0xf bank_mask:0xf
    v_add_f32_dpp v185, v185, v185 row_ror:8 row_mask:0xf bank_mask:0xf
    v_add_f32_dpp v186, v186, v186 row_ror:8 row_mask:0xf bank_mask:0xf
    v_add_f32_dpp v187, v187, v187 row_ror:8 row_mask:0xf bank_mask:0xf
    v_add_f32_dpp v188, v188, v188 row_ror:8 row_mask:0xf bank_mask:0xf
    v_add_f32_dpp v189, v189, v189 row_ror:8 row_mask:0xf bank_mask:0xf
    v_add_f32_dpp v190, v190, v190 row_ror:8 row_mask:0xf bank_mask:0xf
    v_add_f32_dpp v191, v191, v191 row_ror:8 row_mask:0xf bank_mask:0xf
    v_add_f32_dpp v176, v176, v176 row_ror:4 row_mask:0xf bank_mask:0xf
    v_add_f32_dpp v177, v177, v177 row_ror:4 row_mask:0xf bank_mask:0xf
    v_add_f32_dpp v178, v178, v178 row_ror:4 row_mask:0xf bank_mask:0xf
    v_add_f32_dpp v179, v179, v179 row_ror:4 row_mask:0xf bank_mask:0xf
    v_add_f32_dpp v180, v180, v180 row_ror:4 row_mask:0xf bank_mask:0xf
    v_add_f32_dpp v181, v181, v181 row_ror:4 row_mask:0xf bank_mask:0xf
    v_add_f32_dpp v182, v182, v182 row_ror:4 row_mask:0xf bank_mask:0xf
    v_add_f32_dpp v183, v183, v183 row_ror:4 row_mask:0xf bank_mask:0xf
    v_add_f32_dpp v184, v184, v184 row_ror:4 row_mask:0xf bank_mask:0xf
    v_add_f32_dpp v185, v185, v185 row_ror:4 row_mask:0xf bank_mask:0xf
    v_add_f32_dpp v186, v186, v186 row_ror:4 row_mask:0xf bank_mask:0xf
    v_add_f32_dpp v187, v187, v187 row_ror:4 row_mask:0xf bank_mask:0xf
    v_add_f32_dpp v188, v188, v188 row_ror:4 row_mask:0xf bank_mask:0xf
    v_add_f32_dpp v189, v189, v189 row_ror:4 row_mask:0xf bank_mask:0xf
    v_add_f32_dpp v190, v190, v190 row_ror:4 row_mask:0xf bank_mask:0xf
    v_add_f32_dpp v191, v191, v191 row_ror:4 row_mask:0xf bank_mask:0xf
    v_add_f32_dpp v176, v176, v176 row_ror:2 row_mask:0xf bank_mask:0xf
    v_add_f32_dpp v177, v177, v177 row_ror:2 row_mask:0xf bank_mask:0xf
    v_add_f32_dpp v178, v178, v178 row_ror:2 row_mask:0xf bank_mask:0xf
    v_add_f32_dpp v179, v179, v179 row_ror:2 row_mask:0xf bank_mask:0xf
    v_add_f32_dpp v180, v180, v180 row_ror:2 row_mask:0xf bank_mask:0xf
    v_add_f32_dpp v181, v181, v181 row_ror:2 row_mask:0xf bank_mask:0xf
    v_add_f32_dpp v182, v182, v182 row_ror:2 row_mask:0xf bank_mask:0xf
    v_add_f32_dpp v183, v183, v183 row_ror:2 row_mask:0xf bank_mask:0xf
    v_add_f32_dpp v184, v184, v184 row_ror:2 row_mask:0xf bank_mask:0xf
    v_add_f32_dpp v185, v185, v185 row_ror:2 row_mask:0xf bank_mask:0xf
    v_add_f32_dpp v186, v186, v186 row_ror:2 row_mask:0xf bank_mask:0xf
    v_add_f32_dpp v187, v187, v187 row_ror:2 row_mask:0xf bank_mask:0xf
    v_add_f32_dpp v188, v188, v188 row_ror:2 row_mask:0xf bank_mask:0xf
    v_add_f32_dpp v189, v189, v189 row_ror:2 row_mask:0xf bank_mask:0xf
    v_add_f32_dpp v190, v190, v190 row_ror:2 row_mask:0xf bank_mask:0xf
    v_add_f32_dpp v191, v191, v191 row_ror:2 row_mask:0xf bank_mask:0xf
    v_add_f32_dpp v176, v176, v176 row_ror:1 row_mask:0xf bank_mask:0xf
    v_add_f32_dpp v177, v177, v177 row_ror:1 row_mask:0xf bank_mask:0xf
    v_add_f32_dpp v178, v178, v178 row_ror:1 row_mask:0xf bank_mask:0xf
    v_add_f32_dpp v179, v179, v179 row_ror:1 row_mask:0xf bank_mask:0xf
    v_add_f32_dpp v180, v180, v180 row_ror:1 row_mask:0xf bank_mask:0xf
    v_add_f32_dpp v181, v181, v181 row_ror:1 row_mask:0xf bank_mask:0xf
    v_add_f32_dpp v182, v182, v182 row_ror:1 row_mask:0xf bank_mask:0xf
    v_add_f32_dpp v183, v183, v183 row_ror:1 row_mask:0xf bank_mask:0xf
    v_add_f32_dpp v184, v184, v184 row_ror:1 row_mask:0xf bank_mask:0xf
    v_add_f32_dpp v185, v185, v185 row_ror:1 row_mask:0xf bank_mask:0xf
    v_add_f32_dpp v186, v186, v186 row_ror:1 row_mask:0xf bank_mask:0xf
    v_add_f32_dpp v187, v187, v187 row_ror:1 row_mask:0xf bank_mask:0xf
    v_add_f32_dpp v188, v188, v188 row_ror:1 row_mask:0xf bank_mask:0xf
    v_add_f32_dpp v189, v189, v189 row_ror:1 row_mask:0xf bank_mask:0xf
    v_add_f32_dpp v190, v190, v190 row_ror:1 row_mask:0xf bank_mask:0xf
    v_add_f32_dpp v191, v191, v191 row_ror:1 row_mask:0xf bank_mask:0xf
    v_cvt_pk_bf16_f32 v8, v176, v177
    v_lshlrev_b32 v176, 16, v8
    v_and_b32 v177, s97, v8
    v_cvt_pk_bf16_f32 v8, v178, v179
    v_lshlrev_b32 v178, 16, v8
    v_and_b32 v179, s97, v8
    v_cvt_pk_bf16_f32 v8, v180, v181
    v_lshlrev_b32 v180, 16, v8
    v_and_b32 v181, s97, v8
    v_cvt_pk_bf16_f32 v8, v182, v183
    v_lshlrev_b32 v182, 16, v8
    v_and_b32 v183, s97, v8
    v_cvt_pk_bf16_f32 v8, v184, v185
    v_lshlrev_b32 v184, 16, v8
    v_and_b32 v185, s97, v8
    v_cvt_pk_bf16_f32 v8, v186, v187
    v_lshlrev_b32 v186, 16, v8
    v_and_b32 v187, s97, v8
    v_cvt_pk_bf16_f32 v8, v188, v189
    v_lshlrev_b32 v188, 16, v8
    v_and_b32 v189, s97, v8
    v_cvt_pk_bf16_f32 v8, v190, v191
    v_lshlrev_b32 v190, 16, v8
    v_and_b32 v191, s97, v8
    v_lshlrev_b32_e64 v8, 4, v83
    v_add_u32 v8, 155648, v8
    ds_write_b128 v8, v[176:179] offset:0
    ds_write_b128 v8, v[180:183] offset:64
    ds_write_b128 v8, v[184:187] offset:128
    ds_write_b128 v8, v[188:191] offset:192
    s_branch kcd_entry
kab_woj:
    s_cmp_ge_u32 s2, 88
    s_cbranch_scc1 kcd_entry
    s_add_u32 s16, s36, 6684672
    s_addc_u32 s17, s37, 0
    s_and_b32 s17, s17, 0xffff
    s_mov_b32 s18, 720896
    s_mov_b32 s19, 0x00020000
    v_mul_u32_u24 v6, 144, v1
    v_add_u32 v6, 64896, v6
    v_lshrrev_b32 v7, 3, v1
    v_mul_u32_u24 v8, 144, v7
    v_lshl_add_u32 v8, v95, 4, v8
    v_add_u32 v8, 64896, v8
    v_lshrrev_b32_e64 v94, 4, v1
    v_mul_u32_u24 v94, 22528, v94
    v_and_b32_e64 v7, 1, v7
    v_lshl_add_u32 v94, v7, 7, v94
    v_lshl_add_u32 v94, v95, 4, v94
    s_lshl_b32 s23, s2, 8
    s_waitcnt vmcnt(0)
    v_perm_b32 v192, v100, v96, s48
    v_perm_b32 v193, v108, v104, s48
    v_perm_b32 v194, v116, v112, s48
    v_perm_b32 v195, v124, v120, s48
    ds_write_b128 v6, v[192:195] offset:0
    v_perm_b32 v196, v100, v96, s49
    v_perm_b32 v197, v108, v104, s49
    v_perm_b32 v198, v116, v112, s49
    v_perm_b32 v199, v124, v120, s49
    ds_write_b128 v6, v[196:199] offset:16
    v_perm_b32 v200, v101, v97, s48
    v_perm_b32 v201, v109, v105, s48
    v_perm_b32 v202, v117, v113, s48
    v_perm_b32 v203, v125, v121, s48
    ds_write_b128 v6, v[200:203] offset:32
    v_perm_b32 v204, v101, v97, s49
    v_perm_b32 v205, v109, v105, s49
    v_perm_b32 v206, v117, v113, s49
    v_perm_b32 v207, v125, v121, s49
    ds_write_b128 v6, v[204:207] offset:48
    v_perm_b32 v208, v102, v98, s48
    v_perm_b32 v209, v110, v106, s48
    v_perm_b32 v210, v118, v114, s48
    v_perm_b32 v211, v126, v122, s48
    ds_write_b128 v6, v[208:211] offset:64
    v_perm_b32 v212, v102, v98, s49
    v_perm_b32 v213, v110, v106, s49
    v_perm_b32 v214, v118, v114, s49
    v_perm_b32 v215, v126, v122, s49
    ds_write_b128 v6, v[212:215] offset:80
    v_perm_b32 v216, v103, v99, s48
    v_perm_b32 v217, v111, v107, s48
    v_perm_b32 v218, v119, v115, s48
    v_perm_b32 v219, v127, v123, s48
    ds_write_b128 v6, v[216:219] offset:96
    v_perm_b32 v220, v103, v99, s49
    v_perm_b32 v221, v111, v107, s49
    v_perm_b32 v222, v119, v115, s49
    v_perm_b32 v223, v127, v123, s49
    ds_write_b128 v6, v[220:223] offset:112
    s_waitcnt lgkmcnt(0)
    s_nop 0
    ds_read_b128 v[96:99], v8 offset:0
    ds_read_b128 v[100:103], v8 offset:1152
    ds_read_b128 v[104:107], v8 offset:2304
    ds_read_b128 v[108:111], v8 offset:3456
    ds_read_b128 v[112:115], v8 offset:4608
    ds_read_b128 v[116:119], v8 offset:5760
    ds_read_b128 v[120:123], v8 offset:6912
    ds_read_b128 v[124:127], v8 offset:8064
    s_waitcnt lgkmcnt(7)
    buffer_store_dwordx4 v[96:99], v94, s[16:19], s23 offen sc1
    s_add_u32 s23, s23, 90112
    s_waitcnt lgkmcnt(6)
    buffer_store_dwordx4 v[100:103], v94, s[16:19], s23 offen sc1
    s_add_u32 s23, s23, 90112
    s_waitcnt lgkmcnt(5)
    buffer_store_dwordx4 v[104:107], v94, s[16:19], s23 offen sc1
    s_add_u32 s23, s23, 90112
    s_waitcnt lgkmcnt(4)
    buffer_store_dwordx4 v[108:111], v94, s[16:19], s23 offen sc1
    s_add_u32 s23, s23, 90112
    s_waitcnt lgkmcnt(3)
    buffer_store_dwordx4 v[112:115], v94, s[16:19], s23 offen sc1
    s_add_u32 s23, s23, 90112
    s_waitcnt lgkmcnt(2)
    buffer_store_dwordx4 v[116:119], v94, s[16:19], s23 offen sc1
    s_add_u32 s23, s23, 90112
    s_waitcnt lgkmcnt(1)
    buffer_store_dwordx4 v[120:123], v94, s[16:19], s23 offen sc1
    s_add_u32 s23, s23, 90112
    s_waitcnt lgkmcnt(0)
    buffer_store_dwordx4 v[124:127], v94, s[16:19], s23 offen sc1
    s_add_u32 s23, s23, 90112
    s_waitcnt vmcnt(0)
    s_branch kcd_entry
kab_wpj:
    s_add_u32 s16, s36, 5242880
    s_addc_u32 s17, s37, 0
    s_and_b32 s17, s17, 0xffff
    s_mov_b32 s18, 1409024
    s_mov_b32 s19, 0x00020000
    s_add_u32 s24, s36, 524288
    s_addc_u32 s25, s37, 0
    s_and_b32 s25, s25, 0xffff
    s_mov_b32 s26, 180224
    s_mov_b32 s27, 0x00020000
    s_mul_i32 s22, s3, 7168
    s_add_u32 s22, s22, 50560
    v_lshrrev_b32_e64 v4, 4, v1
    v_lshl_add_u32 v6, v4, 3, v95
    v_mul_u32_u24 v6, 144, v6
    v_and_b32_e64 v7, 1, v92
    v_lshl_add_u32 v6, v7, 3, v6
    v_add_u32_e64 v6, s22, v6
    v_mul_u32_u24 v8, 144, v92
    v_lshl_add_u32 v8, v95, 4, v8
    v_add_u32 v8, s22, v8
    v_add_u32 v9, s6, v92
    v_lshrrev_b32 v7, 1, v9
    v_lshlrev_b32 v7, 14, v7
    v_and_b32_e64 v9, 1, v9
    v_lshl_add_u32 v7, v9, 7, v7
    v_lshl_add_u32 v7, v95, 4, v7
    v_cmp_gt_u32 vcc, 6, v92
    v_mov_b32 v9, 0x7fff0000
    s_nop 0
    v_cndmask_b32 v7, v9, v7, vcc
    v_add_u32 v10, s6, v95
    v_lshlrev_b32_e64 v10, 5, v10
    v_bfe_u32 v11, v1, 3, 1
    v_mul_u32_u24 v11, 5632, v11
    v_add_u32_e64 v10, v10, v11
    v_bfe_u32 v11, v1, 4, 1
    v_lshl_add_u32 v10, v11, 4, v10
    v_bfe_u32 v11, v1, 5, 1
    v_lshl_add_u32 v10, v11, 3, v10
    v_cmp_gt_u32 vcc, 6, v95
    s_nop 1
    v_cndmask_b32 v10, v9, v10, vcc
    s_lshl_b32 s23, s5, 10
    s_mul_i32 s21, s5, 11264
    s_mov_b32 s28, 0x3f803f80
    s_waitcnt vmcnt(0)
    s_nop 0
    v_pk_add_f32 v[176:177], v[176:177], v[184:185]
    v_pk_add_f32 v[178:179], v[178:179], v[186:187]
    v_pk_add_f32 v[180:181], v[180:181], v[188:189]
    v_pk_add_f32 v[182:183], v[182:183], v[190:191]
    v_add_f32_dpp v176, v176, v176 row_half_mirror row_mask:0xf bank_mask:0xf
    v_add_f32_dpp v177, v177, v177 row_half_mirror row_mask:0xf bank_mask:0xf
    v_add_f32_dpp v178, v178, v178 row_half_mirror row_mask:0xf bank_mask:0xf
    v_add_f32_dpp v179, v179, v179 row_half_mirror row_mask:0xf bank_mask:0xf
    v_add_f32_dpp v180, v180, v180 row_half_mirror row_mask:0xf bank_mask:0xf
    v_add_f32_dpp v181, v181, v181 row_half_mirror row_mask:0xf bank_mask:0xf
    v_add_f32_dpp v182, v182, v182 row_half_mirror row_mask:0xf bank_mask:0xf
    v_add_f32_dpp v183, v183, v183 row_half_mirror row_mask:0xf bank_mask:0xf
    v_add_f32_dpp v176, v176, v176 quad_perm:[2,3,0,1] row_mask:0xf bank_mask:0xf
    v_add_f32_dpp v177, v177, v177 quad_perm:[2,3,0,1] row_mask:0xf bank_mask:0xf
    v_add_f32_dpp v178, v178, v178 quad_perm:[2,3,0,1] row_mask:0xf bank_mask:0xf
    v_add_f32_dpp v179, v179, v179 quad_perm:[2,3,0,1] row_mask:0xf bank_mask:0xf
    v_add_f32_dpp v180, v180, v180 quad_perm:[2,3,0,1] row_mask:0xf bank_mask:0xf
    v_add_f32_dpp v181, v181, v181 quad_perm:[2,3,0,1] row_mask:0xf bank_mask:0xf
    v_add_f32_dpp v182, v182, v182 quad_perm:[2,3,0,1] row_mask:0xf bank_mask:0xf
    v_add_f32_dpp v183, v183, v183 quad_perm:[2,3,0,1] row_mask:0xf bank_mask:0xf
    v_add_f32_dpp v176, v176, v176 quad_perm:[1,0,3,2] row_mask:0xf bank_mask:0xf
    v_add_f32_dpp v177, v177, v177 quad_perm:[1,0,3,2] row_mask:0xf bank_mask:0xf
    v_add_f32_dpp v178, v178, v178 quad_perm:[1,0,3,2] row_mask:0xf bank_mask:0xf
    v_add_f32_dpp v179, v179, v179 quad_perm:[1,0,3,2] row_mask:0xf bank_mask:0xf
    v_add_f32_dpp v180, v180, v180 quad_perm:[1,0,3,2] row_mask:0xf bank_mask:0xf
    v_add_f32_dpp v181, v181, v181 quad_perm:[1,0,3,2] row_mask:0xf bank_mask:0xf
    v_add_f32_dpp v182, v182, v182 quad_perm:[1,0,3,2] row_mask:0xf bank_mask:0xf
    v_add_f32_dpp v183, v183, v183 quad_perm:[1,0,3,2] row_mask:0xf bank_mask:0xf
    v_cvt_pk_bf16_f32 v184, v176, v177
    v_cvt_pk_bf16_f32 v186, v178, v179
    v_cvt_pk_bf16_f32 v188, v180, v181
    v_cvt_pk_bf16_f32 v190, v182, v183
    v_lshlrev_b32 v160, 16, v184
    v_and_b32 v162, s97, v184
    v_lshlrev_b32 v164, 16, v186
    v_and_b32 v166, s97, v186
    v_lshlrev_b32 v168, 16, v188
    v_and_b32 v170, s97, v188
    v_lshlrev_b32 v172, 16, v190
    v_and_b32 v174, s97, v190
    v_add_f32 v168, 1.0, v168
    v_add_f32 v170, 1.0, v170
    v_add_f32 v172, 1.0, v172
    v_add_f32 v174, 1.0, v174
    v_cvt_pk_bf16_f32 v176, v168, v170
    v_cvt_pk_bf16_f32 v178, v172, v174
    v_lshlrev_b32 v168, 16, v176
    v_and_b32 v170, s97, v176
    v_lshlrev_b32 v172, 16, v178
    v_and_b32 v174, s97, v178
    v_lshlrev_b32 v144, 16, v96
    v_and_b32 v145, s97, v96
    v_lshlrev_b32 v146, 16, v97
    v_and_b32 v147, s97, v97
    v_lshlrev_b32 v148, 16, v98
    v_and_b32 v149, s97, v98
    v_lshlrev_b32 v150, 16, v99
    v_and_b32 v151, s97, v99
    v_pk_mul_f32 v[64:65], v[144:145], v[160:161] op_sel_hi:[1,0]
    v_pk_mul_f32 v[66:67], v[146:147], v[160:161] op_sel_hi:[1,0]
    v_pk_mul_f32 v[68:69], v[148:149], v[160:161] op_sel_hi:[1,0]
    v_pk_mul_f32 v[70:71], v[150:151], v[160:161] op_sel_hi:[1,0]
    v_pk_mul_f32 v[144:145], v[144:145], v[168:169] op_sel_hi:[1,0]
    v_pk_mul_f32 v[146:147], v[146:147], v[168:169] op_sel_hi:[1,0]
    v_pk_mul_f32 v[148:149], v[148:149], v[168:169] op_sel_hi:[1,0]
    v_pk_mul_f32 v[150:151], v[150:151], v[168:169] op_sel_hi:[1,0]
    v_lshlrev_b32 v152, 16, v100
    v_and_b32 v153, s97, v100
    v_lshlrev_b32 v154, 16, v101
    v_and_b32 v155, s97, v101
    v_lshlrev_b32 v156, 16, v102
    v_and_b32 v157, s97, v102
    v_lshlrev_b32 v158, 16, v103
    v_and_b32 v159, s97, v103
    v_pk_fma_f32 v[64:65], v[152:153], v[162:163], v[64:65] op_sel_hi:[1,0,1]
    v_pk_fma_f32 v[66:67], v[154:155], v[162:163], v[66:67] op_sel_hi:[1,0,1]
    v_pk_fma_f32 v[68:69], v[156:157], v[162:163], v[68:69] op_sel_hi:[1,0,1]
    v_pk_fma_f32 v[70:71], v[158:159], v[162:163], v[70:71] op_sel_hi:[1,0,1]
    v_pk_mul_f32 v[152:153], v[152:153], v[170:171] op_sel_hi:[1,0]
    v_pk_mul_f32 v[154:155], v[154:155], v[170:171] op_sel_hi:[1,0]
    v_pk_mul_f32 v[156:157], v[156:157], v[170:171] op_sel_hi:[1,0]
    v_pk_mul_f32 v[158:159], v[158:159], v[170:171] op_sel_hi:[1,0]
    v_cvt_pk_bf16_f32 v192, v144, v152
    v_cvt_pk_bf16_f32 v194, v145, v153
    v_cvt_pk_bf16_f32 v196, v146, v154
    v_cvt_pk_bf16_f32 v198, v147, v155
    v_cvt_pk_bf16_f32 v200, v148, v156
    v_cvt_pk_bf16_f32 v202, v149, v157
    v_cvt_pk_bf16_f32 v204, v150, v158
    v_cvt_pk_bf16_f32 v206, v151, v159
    v_lshlrev_b32 v144, 16, v104
    v_and_b32 v145, s97, v104
    v_lshlrev_b32 v146, 16, v105
    v_and_b32 v147, s97, v105
    v_lshlrev_b32 v148, 16, v106
    v_and_b32 v149, s97, v106
    v_lshlrev_b32 v150, 16, v107
    v_and_b32 v151, s97, v107
    v_pk_fma_f32 v[64:65], v[144:145], v[164:165], v[64:65] op_sel_hi:[1,0,1]
    v_pk_fma_f32 v[66:67], v[146:147], v[164:165], v[66:67] op_sel_hi:[1,0,1]
    v_pk_fma_f32 v[68:69], v[148:149], v[164:165], v[68:69] op_sel_hi:[1,0,1]
    v_pk_fma_f32 v[70:71], v[150:151], v[164:165], v[70:71] op_sel_hi:[1,0,1]
    v_pk_mul_f32 v[144:145], v[144:145], v[172:173] op_sel_hi:[1,0]
    v_pk_mul_f32 v[146:147], v[146:147], v[172:173] op_sel_hi:[1,0]
    v_pk_mul_f32 v[148:149], v[148:149], v[172:173] op_sel_hi:[1,0]
    v_pk_mul_f32 v[150:151], v[150:151], v[172:173] op_sel_hi:[1,0]
    v_lshlrev_b32 v152, 16, v108
    v_and_b32 v153, s97, v108
    v_lshlrev_b32 v154, 16, v109
    v_and_b32 v155, s97, v109
    v_lshlrev_b32 v156, 16, v110
    v_and_b32 v157, s97, v110
    v_lshlrev_b32 v158, 16, v111
    v_and_b32 v159, s97, v111
    v_pk_fma_f32 v[64:65], v[152:153], v[166:167], v[64:65] op_sel_hi:[1,0,1]
    v_pk_fma_f32 v[66:67], v[154:155], v[166:167], v[66:67] op_sel_hi:[1,0,1]
    v_pk_fma_f32 v[68:69], v[156:157], v[166:167], v[68:69] op_sel_hi:[1,0,1]
    v_pk_fma_f32 v[70:71], v[158:159], v[166:167], v[70:71] op_sel_hi:[1,0,1]
    v_pk_mul_f32 v[152:153], v[152:153], v[174:175] op_sel_hi:[1,0]
    v_pk_mul_f32 v[154:155], v[154:155], v[174:175] op_sel_hi:[1,0]
    v_pk_mul_f32 v[156:157], v[156:157], v[174:175] op_sel_hi:[1,0]
    v_pk_mul_f32 v[158:159], v[158:159], v[174:175] op_sel_hi:[1,0]
    v_cvt_pk_bf16_f32 v193, v144, v152
    v_cvt_pk_bf16_f32 v195, v145, v153
    v_cvt_pk_bf16_f32 v197, v146, v154
    v_cvt_pk_bf16_f32 v199, v147, v155
    v_cvt_pk_bf16_f32 v201, v148, v156
    v_cvt_pk_bf16_f32 v203, v149, v157
    v_cvt_pk_bf16_f32 v205, v150, v158
    v_cvt_pk_bf16_f32 v207, v151, v159
    ds_write_b64 v6, v[192:193] offset:0
    ds_write_b64 v6, v[194:195] offset:16
    ds_write_b64 v6, v[196:197] offset:32
    ds_write_b64 v6, v[198:199] offset:48
    ds_write_b64 v6, v[200:201] offset:64
    ds_write_b64 v6, v[202:203] offset:80
    ds_write_b64 v6, v[204:205] offset:96
    ds_write_b64 v6, v[206:207] offset:112
    v_dot2_f32_bf16 v72, v192, s28, 0
    v_dot2_f32_bf16 v73, v194, s28, 0
    v_dot2_f32_bf16 v74, v196, s28, 0
    v_dot2_f32_bf16 v75, v198, s28, 0
    v_dot2_f32_bf16 v76, v200, s28, 0
    v_dot2_f32_bf16 v77, v202, s28, 0
    v_dot2_f32_bf16 v78, v204, s28, 0
    v_dot2_f32_bf16 v79, v206, s28, 0
    v_dot2_f32_bf16 v72, v193, s28, v72
    v_dot2_f32_bf16 v73, v195, s28, v73
    v_dot2_f32_bf16 v74, v197, s28, v74
    v_dot2_f32_bf16 v75, v199, s28, v75
    v_dot2_f32_bf16 v76, v201, s28, v76
    v_dot2_f32_bf16 v77, v203, s28, v77
    v_dot2_f32_bf16 v78, v205, s28, v78
    v_dot2_f32_bf16 v79, v207, s28, v79
    s_waitcnt lgkmcnt(0)
    ds_read_b128 v[96:99], v8 offset:0
    ds_read_b128 v[100:103], v8 offset:1152
    ds_read_b128 v[104:107], v8 offset:2304
    ds_read_b128 v[108:111], v8 offset:3456
    s_waitcnt lgkmcnt(3)
    buffer_store_dwordx4 v[96:99], v7, s[16:19], s23 offen offset:0 sc1
    s_waitcnt lgkmcnt(2)
    buffer_store_dwordx4 v[100:103], v7, s[16:19], s23 offen offset:256 sc1
    s_waitcnt lgkmcnt(1)
    buffer_store_dwordx4 v[104:107], v7, s[16:19], s23 offen offset:512 sc1
    s_waitcnt lgkmcnt(0)
    buffer_store_dwordx4 v[108:111], v7, s[16:19], s23 offen offset:768 sc1
    v_add_f32_dpp v80, v72, v72 row_ror:8 row_mask:0xf bank_mask:0x3
    s_nop 1
    v_add_f32_dpp v80, v64, v64 row_ror:8 row_mask:0xf bank_mask:0xc
    v_add_f32_dpp v81, v73, v73 row_ror:8 row_mask:0xf bank_mask:0x3
    s_nop 1
    v_add_f32_dpp v81, v65, v65 row_ror:8 row_mask:0xf bank_mask:0xc
    v_add_f32_dpp v82, v74, v74 row_ror:8 row_mask:0xf bank_mask:0x3
    s_nop 1
    v_add_f32_dpp v82, v66, v66 row_ror:8 row_mask:0xf bank_mask:0xc
    v_add_f32_dpp v83, v75, v75 row_ror:8 row_mask:0xf bank_mask:0x3
    s_nop 1
    v_add_f32_dpp v83, v67, v67 row_ror:8 row_mask:0xf bank_mask:0xc
    v_add_f32_dpp v84, v76, v76 row_ror:8 row_mask:0xf bank_mask:0x3
    s_nop 1
    v_add_f32_dpp v84, v68, v68 row_ror:8 row_mask:0xf bank_mask:0xc
    v_add_f32_dpp v85, v77, v77 row_ror:8 row_mask:0xf bank_mask:0x3
    s_nop 1
    v_add_f32_dpp v85, v69, v69 row_ror:8 row_mask:0xf bank_mask:0xc
    v_add_f32_dpp v86, v78, v78 row_ror:8 row_mask:0xf bank_mask:0x3
    s_nop 1
    v_add_f32_dpp v86, v70, v70 row_ror:8 row_mask:0xf bank_mask:0xc
    v_add_f32_dpp v87, v79, v79 row_ror:8 row_mask:0xf bank_mask:0x3
    s_nop 1
    v_add_f32_dpp v87, v71, v71 row_ror:8 row_mask:0xf bank_mask:0xc
    v_permlane16_swap_b32 v80, v84
    v_permlane16_swap_b32 v81, v85
    v_permlane16_swap_b32 v82, v86
    v_permlane16_swap_b32 v83, v87
    v_add_f32 v80, v80, v84
    v_add_f32 v81, v81, v85
    v_add_f32 v82, v82, v86
    v_add_f32 v83, v83, v87
    s_nop 0
    v_permlane32_swap_b32 v80, v82
    v_permlane32_swap_b32 v81, v83
    v_add_f32 v80, v80, v82
    v_add_f32 v81, v81, v83
    buffer_store_dwordx2 v[80:81], v10, s[24:27], s21 offen sc1
    s_waitcnt vmcnt(0)
kcd_entry:
    s_setprio 0
    s_load_dwordx4 s[84:87], s[0:1], 72
    s_load_dwordx2 s[38:39], s[0:1], 112
    s_and_b32 s6, s2, 7
    s_lshr_b32 s5, s2, 3
    s_lshr_b32 s4, s6, 1
    s_lshl_b32 s4, s4, 3
    s_lshr_b32 s7, s5, 2
    s_add_u32 s4, s4, s7
    s_and_b32 s5, s5, 3
    s_and_b32 s6, s6, 1
    s_lshl_b32 s6, s6, 2
    s_add_u32 s5, s5, s6
    v_lshlrev_b32 v4, 4, v1
    s_and_b32 s3, s11, 3
    s_lshr_b32 s7, s3, 1
    s_and_b32 s8, s3, 1
    s_mul_i32 s6, s5, 5
    s_lshr_b32 s40, s5, 1
    s_min_u32 s40, s40, 3
    s_add_u32 s40, s40, s6
    s_add_u32 s40, s40, 43
    s_add_u32 s41, s5, 1
    s_lshr_b32 s41, s41, 1
    s_min_u32 s41, s41, 3
    s_add_u32 s41, s41, s6
    s_lshr_b32 s42, 0x2a, s5
    s_and_b32 s42, s42, 1
    s_add_u32 s42, s42, 5
    s_lshr_b32 s43, 0x15, s5
    s_and_b32 s43, s43, 1
    s_add_u32 s43, s43, 5
    v_and_b32 v3, 15, v1
    v_lshrrev_b32_e64 v9, 4, v1
    v_bfe_u32 v15, v1, 2, 2
    v_lshl_add_u32 v16, v9, 3, v15
    v_lshlrev_b32 v16, 7, v16
    v_and_b32 v17, 3, v1
    v_lshl_add_u32 v16, v17, 3, v16
    v_add_u32 v16, 4096, v16
    v_lshrrev_b32 v15, 1, v15
    v_and_b32 v17, 1, v9
    v_lshl_or_b32 v15, v17, 1, v15
    s_mov_b32 s27, 0x3727c5ac
    s_lshl_b32 s9, s5, 1
    s_add_u32 s9, s9, s4
    s_and_b32 s9, s9, 0
    s_cmp_lt_u32 s11, 4
    s_cbranch_scc1 kcd_comp
    v_lshrrev_b32 v10, 3, v1
    v_and_b32 v8, 2, v10
    s_lshl_b32 s16, s8, 2
    v_or_b32 v8, s16, v8
    v_and_b32 v11, 7, v1
    v_xor_b32 v8, v8, v11
    v_lshlrev_b32 v8, 4, v8
    s_lshl_b32 s16, s3, 3
    v_add_u32 v10, s16, v10
    v_lshl_add_u32 v8, v10, 7, v8
    s_mul_i32 s16, s8, 49152
    v_add_u32_e64 v5, s16, v4
    v_add_u32 v6, 16384, v5
    v_add_u32 v7, 32768, v5
    s_lshl_b32 s21, s4, 16
    s_lshl_b32 s22, s3, 10
    s_add_u32 s22, s22, 4096
    s_mul_i32 s23, s3, 3072
    s_add_u32 s23, s23, 69632
    s_lshl_b32 s24, s7, 10
    s_waitcnt lgkmcnt(0)
    s_add_u32 s12, s36, 1048576
    s_addc_u32 s13, s37, 0
    s_and_b32 s13, s13, 0xffff
    s_mov_b32 s14, 2097152
    s_mov_b32 s15, 0x00020000
    s_lshl_b32 s16, s40, 14
    s_add_u32 s16, s16, 5242880
    s_lshl_b32 s17, s42, 14
    s_add_u32 s64, s36, s16
    s_addc_u32 s65, s37, 0
    s_and_b32 s65, s65, 0xffff
    s_mov_b32 s66, s17
    s_mov_b32 s67, 0x00020000
    s_lshl_b32 s16, s41, 14
    s_add_u32 s16, s16, 5242880
    s_lshl_b32 s17, s43, 14
    s_add_u32 s68, s36, s16
    s_addc_u32 s69, s37, 0
    s_and_b32 s69, s69, 0xffff
    s_mov_b32 s70, s17
    s_mov_b32 s71, 0x00020000
    v_xor_b32 v17, s3, v15
    v_lshl_add_u32 v14, v17, 5, v16
    v_mov_b32 v20, 0
    v_mov_b32 v21, 0
    v_mov_b32 v12, 0
    v_mov_b32 v13, 0
    s_mov_b32 s26, 0x3f803f80
    s_add_u32 s32, s36, 131072
    s_addc_u32 s33, s37, 0
    s_and_b32 s33, s33, 0xffff
    s_mov_b32 s34, 131072
    s_mov_b32 s35, 0x00020000
    s_lshl_b32 s44, s4, 12
    s_lshl_b32 s45, s5, 9
    s_add_u32 s45, s45, s44
    v_lshlrev_b32 v18, 3, v1
    s_cmp_eq_u32 s7, 0
    s_cselect_b32 s16, s40, s41
    s_cselect_b32 s17, s42, s43
    s_lshl_b32 s49, s16, 6
    s_mul_i32 s18, s8, 5632
    s_add_u32 s49, s49, s18
    s_lshl_b32 s17, s17, 2
    s_add_u32 s72, s36, 524288
    s_addc_u32 s73, s37, 0
    s_and_b32 s73, s73, 0xffff
    s_mov_b32 s74, 180224
    s_mov_b32 s75, 0x00020000
    v_and_b32 v11, 31, v1
    v_lshrrev_b32 v10, 5, v1
    v_mul_u32_u24 v10, 11264, v10
    v_lshl_add_u32 v10, v11, 4, v10
    v_cmp_gt_u32 vcc, s17, v11
    v_mov_b32 v19, 0x7fff0000
    s_nop 0
    v_cndmask_b32 v10, v19, v10, vcc
    s_mul_i32 s16, s3, 384
    v_lshl_add_u32 v19, v11, 4, s16
    s_add_u32 s76, s36, 32768
    s_addc_u32 s77, s37, 0
    s_and_b32 s77, s77, 0xffff
    s_mov_b32 s78, 65536
    s_mov_b32 s79, 0x00020000
    s_lshr_b32 s16, s2, 3
    s_and_b32 s16, s16, 15
    s_lshl_b32 s16, s16, 7
    v_lshl_add_u32 v72, v1, 11, s16
    s_and_b32 s16, s2, 7
    s_lshl_b32 s16, s16, 11
    v_lshl_add_u32 v73, v3, 7, s16
    v_mov_b32 v74, 1
    s_barrier
    s_cmp_lg_u32 s3, 2
    s_cbranch_scc1 kcd_g1_x
    s_mov_b32 s62, 49152
    s_mov_b64 exec, 0xff
    buffer_atomic_add v74, v72, s[76:79], s62 offen sc1
    s_mov_b64 exec, -1
    s_mov_b32 s47, 0
    s_sleep 16
kcd_g1_p:
    buffer_load_dword v75, v73, s[76:79], s62 offen sc1
    s_add_u32 s47, s47, 1
    s_waitcnt vmcnt(0)
    v_cmp_gt_u32 vcc, 16, v75
    s_nop 4
    s_cbranch_vccz kcd_g1_x
    s_sleep 4
    s_cmp_lt_u32 s47, 1048576
    s_cbranch_scc1 kcd_g1_p
kcd_g1_x:
    s_barrier
    s_add_u32 s10, s9, 0
    s_and_b32 s10, s10, 7
    s_lshl_b32 s19, s10, 13
    s_add_u32 s19, s19, s21
    s_add_u32 m0, s22, 0
    s_add_u32 s25, s19, 0
    buffer_load_dwordx4 v8, s[12:15], s25 offen sc1 lds
    s_add_u32 m0, s22, 4096
    s_add_u32 s25, s19, 4096
    buffer_load_dwordx4 v8, s[12:15], s25 offen sc1 lds
    s_lshl_b32 s25, s10, 11
    s_add_u32 s25, s25, s24
    s_add_u32 m0, s23, 0
    s_nop 0
    buffer_load_dwordx4 v5, s[64:67], s25 offen sc1 lds
    s_add_u32 m0, s23, 1024
    s_nop 0
    buffer_load_dwordx4 v6, s[64:67], s25 offen sc1 lds
    s_add_u32 m0, s23, 2048
    s_nop 0
    buffer_load_dwordx4 v7, s[64:67], s25 offen sc1 lds
    s_add_u32 s10, s9, 1
    s_and_b32 s10, s10, 7
    s_lshl_b32 s19, s10, 13
    s_add_u32 s19, s19, s21
    s_add_u32 m0, s22, 8192
    s_add_u32 s25, s19, 0
    buffer_load_dwordx4 v8, s[12:15], s25 offen sc1 lds
    s_add_u32 m0, s22, 12288
    s_add_u32 s25, s19, 4096
    buffer_load_dwordx4 v8, s[12:15], s25 offen sc1 lds
    s_lshl_b32 s25, s10, 11
    s_add_u32 s25, s25, s24
    s_add_u32 m0, s23, 12288
    s_nop 0
    buffer_load_dwordx4 v5, s[64:67], s25 offen sc1 lds
    s_add_u32 m0, s23, 13312
    s_nop 0
    buffer_load_dwordx4 v6, s[64:67], s25 offen sc1 lds
    s_add_u32 m0, s23, 14336
    s_nop 0
    buffer_load_dwordx4 v7, s[64:67], s25 offen sc1 lds
    s_add_u32 s10, s9, 2
    s_and_b32 s10, s10, 7
    s_lshl_b32 s19, s10, 13
    s_add_u32 s19, s19, s21
    s_add_u32 m0, s22, 16384
    s_add_u32 s25, s19, 0
    buffer_load_dwordx4 v8, s[12:15], s25 offen sc1 lds
    s_add_u32 m0, s22, 20480
    s_add_u32 s25, s19, 4096
    buffer_load_dwordx4 v8, s[12:15], s25 offen sc1 lds
    s_lshl_b32 s25, s10, 11
    s_add_u32 s25, s25, s24
    s_add_u32 m0, s23, 24576
    s_nop 0
    buffer_load_dwordx4 v5, s[64:67], s25 offen sc1 lds
    s_add_u32 m0, s23, 25600
    s_nop 0
    buffer_load_dwordx4 v6, s[64:67], s25 offen sc1 lds
    s_add_u32 m0, s23, 26624
    s_nop 0
    buffer_load_dwordx4 v7, s[64:67], s25 offen sc1 lds
    s_setprio 2
    s_waitcnt vmcnt(10)
    s_barrier
    s_add_u32 s10, s9, 3
    s_and_b32 s10, s10, 7
    s_lshl_b32 s19, s10, 13
    s_add_u32 s19, s19, s21
    s_add_u32 m0, s22, 24576
    s_add_u32 s25, s19, 0
    buffer_load_dwordx4 v8, s[12:15], s25 offen sc1 lds
    s_add_u32 m0, s22, 28672
    s_add_u32 s25, s19, 4096
    buffer_load_dwordx4 v8, s[12:15], s25 offen sc1 lds
    s_lshl_b32 s25, s10, 11
    s_add_u32 s25, s25, s24
    s_add_u32 m0, s23, 36864
    s_nop 0
    buffer_load_dwordx4 v5, s[64:67], s25 offen sc1 lds
    s_add_u32 m0, s23, 37888
    s_nop 0
    buffer_load_dwordx4 v6, s[64:67], s25 offen sc1 lds
    s_add_u32 m0, s23, 38912
    s_nop 0
    buffer_load_dwordx4 v7, s[64:67], s25 offen sc1 lds
    ds_read_b64_tr_b16 v[24:25], v14 offset:0
    ds_read_b64_tr_b16 v[26:27], v14 offset:512
    ds_read_b64_tr_b16 v[28:29], v14 offset:4096
    ds_read_b64_tr_b16 v[30:31], v14 offset:4608
    s_waitcnt vmcnt(10)
    s_barrier
    s_add_u32 s10, s9, 4
    s_and_b32 s10, s10, 7
    s_lshl_b32 s19, s10, 13
    s_add_u32 s19, s19, s21
    s_add_u32 m0, s22, 32768
    s_add_u32 s25, s19, 0
    buffer_load_dwordx4 v8, s[12:15], s25 offen sc1 lds
    s_waitcnt lgkmcnt(0)
    s_nop 0
    v_dot2_f32_bf16 v20, v24, s26, v20
    v_dot2_f32_bf16 v21, v24, v24, v21
    v_dot2_f32_bf16 v12, v25, s26, v12
    s_add_u32 m0, s22, 36864
    s_add_u32 s25, s19, 4096
    buffer_load_dwordx4 v8, s[12:15], s25 offen sc1 lds
    v_dot2_f32_bf16 v13, v25, v25, v13
    v_dot2_f32_bf16 v20, v26, s26, v20
    v_dot2_f32_bf16 v21, v26, v26, v21
    v_dot2_f32_bf16 v12, v27, s26, v12
    s_lshl_b32 s25, s10, 11
    s_add_u32 s25, s25, s24
    s_add_u32 m0, s23, 49152
    s_nop 0
    buffer_load_dwordx4 v5, s[64:67], s25 offen sc1 lds
    v_dot2_f32_bf16 v13, v27, v27, v13
    v_dot2_f32_bf16 v20, v28, s26, v20
    v_dot2_f32_bf16 v21, v28, v28, v21
    v_dot2_f32_bf16 v12, v29, s26, v12
    s_add_u32 m0, s23, 50176
    s_nop 0
    buffer_load_dwordx4 v6, s[64:67], s25 offen sc1 lds
    v_dot2_f32_bf16 v13, v29, v29, v13
    v_dot2_f32_bf16 v20, v30, s26, v20
    v_dot2_f32_bf16 v21, v30, v30, v21
    v_dot2_f32_bf16 v12, v31, s26, v12
    s_add_u32 m0, s23, 51200
    s_nop 0
    buffer_load_dwordx4 v7, s[64:67], s25 offen sc1 lds
    v_dot2_f32_bf16 v13, v31, v31, v13
    ds_read_b64_tr_b16 v[32:33], v14 offset:8192
    ds_read_b64_tr_b16 v[34:35], v14 offset:8704
    ds_read_b64_tr_b16 v[36:37], v14 offset:12288
    ds_read_b64_tr_b16 v[38:39], v14 offset:12800
    s_waitcnt vmcnt(10)
    s_barrier
    s_add_u32 s10, s9, 5
    s_and_b32 s10, s10, 7
    s_lshl_b32 s19, s10, 13
    s_add_u32 s19, s19, s21
    s_add_u32 m0, s22, 40960
    s_add_u32 s25, s19, 0
    buffer_load_dwordx4 v8, s[12:15], s25 offen sc1 lds
    s_waitcnt lgkmcnt(0)
    s_nop 0
    v_dot2_f32_bf16 v20, v32, s26, v20
    v_dot2_f32_bf16 v21, v32, v32, v21
    v_dot2_f32_bf16 v12, v33, s26, v12
    s_add_u32 m0, s22, 45056
    s_add_u32 s25, s19, 4096
    buffer_load_dwordx4 v8, s[12:15], s25 offen sc1 lds
    v_dot2_f32_bf16 v13, v33, v33, v13
    v_dot2_f32_bf16 v20, v34, s26, v20
    v_dot2_f32_bf16 v21, v34, v34, v21
    v_dot2_f32_bf16 v12, v35, s26, v12
    s_lshl_b32 s25, s10, 11
    s_add_u32 s25, s25, s24
    s_add_u32 m0, s23, 61440
    s_nop 0
    buffer_load_dwordx4 v5, s[64:67], s25 offen sc1 lds
    v_dot2_f32_bf16 v13, v35, v35, v13
    v_dot2_f32_bf16 v20, v36, s26, v20
    v_dot2_f32_bf16 v21, v36, v36, v21
    v_dot2_f32_bf16 v12, v37, s26, v12
    s_add_u32 m0, s23, 62464
    s_nop 0
    buffer_load_dwordx4 v6, s[64:67], s25 offen sc1 lds
    v_dot2_f32_bf16 v13, v37, v37, v13
    v_dot2_f32_bf16 v20, v38, s26, v20
    v_dot2_f32_bf16 v21, v38, v38, v21
    v_dot2_f32_bf16 v12, v39, s26, v12
    s_add_u32 m0, s23, 63488
    s_nop 0
    buffer_load_dwordx4 v7, s[64:67], s25 offen sc1 lds
    v_dot2_f32_bf16 v13, v39, v39, v13
    ds_read_b64_tr_b16 v[24:25], v14 offset:16384
    ds_read_b64_tr_b16 v[26:27], v14 offset:16896
    ds_read_b64_tr_b16 v[28:29], v14 offset:20480
    ds_read_b64_tr_b16 v[30:31], v14 offset:20992
    s_waitcnt vmcnt(10)
    s_barrier
    s_add_u32 s10, s9, 6
    s_and_b32 s10, s10, 7
    s_lshl_b32 s19, s10, 13
    s_add_u32 s19, s19, s21
    s_add_u32 m0, s22, 49152
    s_add_u32 s25, s19, 0
    buffer_load_dwordx4 v8, s[12:15], s25 offen sc1 lds
    s_waitcnt lgkmcnt(0)
    s_nop 0
    v_dot2_f32_bf16 v20, v24, s26, v20
    v_dot2_f32_bf16 v21, v24, v24, v21
    v_dot2_f32_bf16 v12, v25, s26, v12
    s_add_u32 m0, s22, 53248
    s_add_u32 s25, s19, 4096
    buffer_load_dwordx4 v8, s[12:15], s25 offen sc1 lds
    v_dot2_f32_bf16 v13, v25, v25, v13
    v_dot2_f32_bf16 v20, v26, s26, v20
    v_dot2_f32_bf16 v21, v26, v26, v21
    v_dot2_f32_bf16 v12, v27, s26, v12
    s_lshl_b32 s25, s10, 11
    s_add_u32 s25, s25, s24
    s_add_u32 m0, s23, 73728
    s_nop 0
    buffer_load_dwordx4 v5, s[64:67], s25 offen sc1 lds
    v_dot2_f32_bf16 v13, v27, v27, v13
    v_dot2_f32_bf16 v20, v28, s26, v20
    v_dot2_f32_bf16 v21, v28, v28, v21
    v_dot2_f32_bf16 v12, v29, s26, v12
    s_add_u32 m0, s23, 74752
    s_nop 0
    buffer_load_dwordx4 v6, s[64:67], s25 offen sc1 lds
    v_dot2_f32_bf16 v13, v29, v29, v13
    v_dot2_f32_bf16 v20, v30, s26, v20
    v_dot2_f32_bf16 v21, v30, v30, v21
    v_dot2_f32_bf16 v12, v31, s26, v12
    s_add_u32 m0, s23, 75776
    s_nop 0
    buffer_load_dwordx4 v7, s[64:67], s25 offen sc1 lds
    v_dot2_f32_bf16 v13, v31, v31, v13
    s_add_u32 s25, s49, 0
    buffer_load_dwordx4 v[40:43], v10, s[72:75], s25 offen sc1
    s_add_u32 s25, s49, 22528
    buffer_load_dwordx4 v[44:47], v10, s[72:75], s25 offen sc1
    s_add_u32 s25, s49, 45056
    buffer_load_dwordx4 v[48:51], v10, s[72:75], s25 offen sc1
    s_add_u32 s25, s49, 67584
    buffer_load_dwordx4 v[52:55], v10, s[72:75], s25 offen sc1
    s_add_u32 s25, s49, 90112
    buffer_load_dwordx4 v[56:59], v10, s[72:75], s25 offen sc1
    s_add_u32 s25, s49, 112640
    buffer_load_dwordx4 v[60:63], v10, s[72:75], s25 offen sc1
    s_add_u32 s25, s49, 135168
    buffer_load_dwordx4 v[64:67], v10, s[72:75], s25 offen sc1
    s_add_u32 s25, s49, 157696
    buffer_load_dwordx4 v[68:71], v10, s[72:75], s25 offen sc1
    ds_read_b64_tr_b16 v[32:33], v14 offset:24576
    ds_read_b64_tr_b16 v[34:35], v14 offset:25088
    ds_read_b64_tr_b16 v[36:37], v14 offset:28672
    ds_read_b64_tr_b16 v[38:39], v14 offset:29184
    s_waitcnt vmcnt(18)
    s_barrier
    s_add_u32 s10, s9, 7
    s_and_b32 s10, s10, 7
    s_lshl_b32 s19, s10, 13
    s_add_u32 s19, s19, s21
    s_add_u32 m0, s22, 57344
    s_add_u32 s25, s19, 0
    buffer_load_dwordx4 v8, s[12:15], s25 offen sc1 lds
    s_waitcnt lgkmcnt(0)
    v_dot2_f32_bf16 v20, v32, s26, v20
    v_dot2_f32_bf16 v21, v32, v32, v21
    v_dot2_f32_bf16 v12, v33, s26, v12
    s_add_u32 m0, s22, 61440
    s_add_u32 s25, s19, 4096
    buffer_load_dwordx4 v8, s[12:15], s25 offen sc1 lds
    v_dot2_f32_bf16 v13, v33, v33, v13
    v_dot2_f32_bf16 v20, v34, s26, v20
    v_dot2_f32_bf16 v21, v34, v34, v21
    v_dot2_f32_bf16 v12, v35, s26, v12
    s_lshl_b32 s25, s10, 11
    s_add_u32 s25, s25, s24
    s_add_u32 m0, s23, 0
    s_nop 0
    buffer_load_dwordx4 v5, s[64:67], s25 offen sc1 lds
    v_dot2_f32_bf16 v13, v35, v35, v13
    v_dot2_f32_bf16 v20, v36, s26, v20
    v_dot2_f32_bf16 v21, v36, v36, v21
    v_dot2_f32_bf16 v12, v37, s26, v12
    s_add_u32 m0, s23, 1024
    s_nop 0
    buffer_load_dwordx4 v6, s[64:67], s25 offen sc1 lds
    v_dot2_f32_bf16 v13, v37, v37, v13
    v_dot2_f32_bf16 v20, v38, s26, v20
    v_dot2_f32_bf16 v21, v38, v38, v21
    v_dot2_f32_bf16 v12, v39, s26, v12
    s_add_u32 m0, s23, 2048
    s_nop 0
    buffer_load_dwordx4 v7, s[64:67], s25 offen sc1 lds
    v_dot2_f32_bf16 v13, v39, v39, v13
    ds_read_b64_tr_b16 v[24:25], v14 offset:32768
    ds_read_b64_tr_b16 v[26:27], v14 offset:33280
    ds_read_b64_tr_b16 v[28:29], v14 offset:36864
    ds_read_b64_tr_b16 v[30:31], v14 offset:37376
    s_waitcnt vmcnt(18)
    s_barrier
    s_add_u32 s10, s9, 0
    s_and_b32 s10, s10, 7
    s_lshl_b32 s25, s10, 11
    s_add_u32 s25, s25, s24
    s_add_u32 m0, s23, 12288
    s_nop 0
    buffer_load_dwordx4 v5, s[68:71], s25 offen sc1 lds
    s_waitcnt lgkmcnt(0)
    v_dot2_f32_bf16 v20, v24, s26, v20
    v_dot2_f32_bf16 v21, v24, v24, v21
    v_dot2_f32_bf16 v12, v25, s26, v12
    v_dot2_f32_bf16 v13, v25, v25, v13
    v_dot2_f32_bf16 v20, v26, s26, v20
    s_add_u32 m0, s23, 13312
    s_nop 0
    s_nop 0
    buffer_load_dwordx4 v6, s[68:71], s25 offen sc1 lds
    v_dot2_f32_bf16 v21, v26, v26, v21
    v_dot2_f32_bf16 v12, v27, s26, v12
    v_dot2_f32_bf16 v13, v27, v27, v13
    v_dot2_f32_bf16 v20, v28, s26, v20
    v_dot2_f32_bf16 v21, v28, v28, v21
    v_dot2_f32_bf16 v12, v29, s26, v12
    s_add_u32 m0, s23, 14336
    s_nop 0
    s_nop 0
    buffer_load_dwordx4 v7, s[68:71], s25 offen sc1 lds
    v_dot2_f32_bf16 v13, v29, v29, v13
    v_dot2_f32_bf16 v20, v30, s26, v20
    v_dot2_f32_bf16 v21, v30, v30, v21
    v_dot2_f32_bf16 v12, v31, s26, v12
    v_dot2_f32_bf16 v13, v31, v31, v13
    ds_read_b64_tr_b16 v[32:33], v14 offset:40960
    ds_read_b64_tr_b16 v[34:35], v14 offset:41472
    ds_read_b64_tr_b16 v[36:37], v14 offset:45056
    ds_read_b64_tr_b16 v[38:39], v14 offset:45568
    s_waitcnt vmcnt(16)
    s_barrier
    s_waitcnt vmcnt(8)
    s_add_u32 s10, s9, 1
    s_and_b32 s10, s10, 7
    s_lshl_b32 s25, s10, 11
    s_add_u32 s25, s25, s24
    s_add_u32 m0, s23, 24576
    s_nop 0
    buffer_load_dwordx4 v5, s[68:71], s25 offen sc1 lds
    s_waitcnt lgkmcnt(0)
    s_nop 0
    v_dot2_f32_bf16 v20, v32, s26, v20
    v_dot2_f32_bf16 v21, v32, v32, v21
    v_dot2_f32_bf16 v12, v33, s26, v12
    v_dot2_f32_bf16 v13, v33, v33, v13
    v_dot2_f32_bf16 v20, v34, s26, v20
    v_dot2_f32_bf16 v21, v34, v34, v21
    v_dot2_f32_bf16 v12, v35, s26, v12
    v_dot2_f32_bf16 v13, v35, v35, v13
    v_dot2_f32_bf16 v20, v36, s26, v20
    v_dot2_f32_bf16 v21, v36, v36, v21
    v_dot2_f32_bf16 v12, v37, s26, v12
    v_dot2_f32_bf16 v13, v37, v37, v13
    v_dot2_f32_bf16 v20, v38, s26, v20
    v_dot2_f32_bf16 v21, v38, v38, v21
    s_add_u32 m0, s23, 25600
    s_nop 0
    s_nop 0
    buffer_load_dwordx4 v6, s[68:71], s25 offen sc1 lds
    v_dot2_f32_bf16 v12, v39, s26, v12
    v_dot2_f32_bf16 v13, v39, v39, v13
    v_pk_add_f32 v[40:41], v[40:41], v[56:57]
    v_pk_add_f32 v[42:43], v[42:43], v[58:59]
    v_pk_add_f32 v[44:45], v[44:45], v[60:61]
    v_pk_add_f32 v[46:47], v[46:47], v[62:63]
    v_pk_add_f32 v[48:49], v[48:49], v[64:65]
    v_pk_add_f32 v[50:51], v[50:51], v[66:67]
    v_pk_add_f32 v[52:53], v[52:53], v[68:69]
    v_pk_add_f32 v[54:55], v[54:55], v[70:71]
    v_pk_add_f32 v[40:41], v[40:41], v[48:49]
    v_pk_add_f32 v[42:43], v[42:43], v[50:51]
    v_pk_add_f32 v[44:45], v[44:45], v[52:53]
    v_pk_add_f32 v[46:47], v[46:47], v[54:55]
    v_pk_add_f32 v[40:41], v[40:41], v[44:45]
    s_add_u32 m0, s23, 26624
    s_nop 0
    buffer_load_dwordx4 v7, s[68:71], s25 offen sc1 lds
    v_pk_add_f32 v[42:43], v[42:43], v[46:47]
    v_mov_b32 v44, v40
    v_mov_b32 v45, v41
    v_mov_b32 v46, v42
    v_mov_b32 v47, v43
    s_nop 1
    v_permlane32_swap_b32 v40, v44
    v_permlane32_swap_b32 v41, v45
    v_permlane32_swap_b32 v42, v46
    v_permlane32_swap_b32 v43, v47
    v_pk_add_f32 v[40:41], v[40:41], v[44:45]
    v_pk_add_f32 v[42:43], v[42:43], v[46:47]
    s_mov_b64 exec, 0xffffff
    ds_write_b128 v19, v[40:43] offset:2048
    s_mov_b64 exec, -1
    ds_read_b64_tr_b16 v[24:25], v14 offset:49152
    ds_read_b64_tr_b16 v[26:27], v14 offset:49664
    ds_read_b64_tr_b16 v[28:29], v14 offset:53248
    ds_read_b64_tr_b16 v[30:31], v14 offset:53760
    s_waitcnt vmcnt(6)
    s_barrier
    s_add_u32 s10, s9, 2
    s_and_b32 s10, s10, 7
    s_lshl_b32 s25, s10, 11
    s_add_u32 s25, s25, s24
    s_add_u32 m0, s23, 36864
    s_nop 0
    buffer_load_dwordx4 v5, s[68:71], s25 offen sc1 lds
    s_waitcnt lgkmcnt(0)
    v_dot2_f32_bf16 v20, v24, s26, v20
    v_dot2_f32_bf16 v21, v24, v24, v21
    v_dot2_f32_bf16 v12, v25, s26, v12
    v_dot2_f32_bf16 v13, v25, v25, v13
    v_dot2_f32_bf16 v20, v26, s26, v20
    s_add_u32 m0, s23, 37888
    s_nop 0
    buffer_load_dwordx4 v6, s[68:71], s25 offen sc1 lds
    v_dot2_f32_bf16 v21, v26, v26, v21
    v_dot2_f32_bf16 v12, v27, s26, v12
    v_dot2_f32_bf16 v13, v27, v27, v13
    v_dot2_f32_bf16 v20, v28, s26, v20
    v_dot2_f32_bf16 v21, v28, v28, v21
    v_dot2_f32_bf16 v12, v29, s26, v12
    s_add_u32 m0, s23, 38912
    s_nop 0
    s_nop 0
    buffer_load_dwordx4 v7, s[68:71], s25 offen sc1 lds
    v_dot2_f32_bf16 v13, v29, v29, v13
    v_dot2_f32_bf16 v20, v30, s26, v20
    v_dot2_f32_bf16 v21, v30, v30, v21
    v_dot2_f32_bf16 v12, v31, s26, v12
    v_dot2_f32_bf16 v13, v31, v31, v13
    ds_read_b64_tr_b16 v[32:33], v14 offset:57344
    ds_read_b64_tr_b16 v[34:35], v14 offset:57856
    ds_read_b64_tr_b16 v[36:37], v14 offset:61440
    ds_read_b64_tr_b16 v[38:39], v14 offset:61952
    s_waitcnt vmcnt(6)
    s_barrier
    s_waitcnt lgkmcnt(0)
    s_nop 0
    v_dot2_f32_bf16 v20, v32, s26, v20
    v_dot2_f32_bf16 v21, v32, v32, v21
    v_dot2_f32_bf16 v12, v33, s26, v12
    v_dot2_f32_bf16 v13, v33, v33, v13
    v_dot2_f32_bf16 v20, v34, s26, v20
    v_dot2_f32_bf16 v21, v34, v34, v21
    v_dot2_f32_bf16 v12, v35, s26, v12
    v_dot2_f32_bf16 v13, v35, v35, v13
    v_dot2_f32_bf16 v20, v36, s26, v20
    v_dot2_f32_bf16 v21, v36, v36, v21
    v_dot2_f32_bf16 v12, v37, s26, v12
    v_dot2_f32_bf16 v13, v37, v37, v13
    v_dot2_f32_bf16 v20, v38, s26, v20
    v_dot2_f32_bf16 v21, v38, v38, v21
    v_dot2_f32_bf16 v12, v39, s26, v12
    v_dot2_f32_bf16 v13, v39, v39, v13
    s_nop 1
    v_add_f32 v20, v20, v12
    v_add_f32 v21, v21, v13
    v_mov_b32 v17, v20
    s_nop 1
    v_permlane16_swap_b32 v17, v20
    v_add_f32 v20, v20, v17
    v_mov_b32 v17, v20
    s_nop 1
    v_permlane32_swap_b32 v17, v20
    v_add_f32 v20, v20, v17
    v_mov_b32 v17, v21
    s_nop 1
    v_permlane16_swap_b32 v17, v21
    v_add_f32 v21, v21, v17
    v_mov_b32 v17, v21
    s_nop 1
    v_permlane32_swap_b32 v17, v21
    v_add_f32_e64 v21, v21, v17
    s_mov_b32 s46, 0x3b000000
    v_mul_f32 v20, s46, v20
    v_mul_f32 v21, s46, v21
    v_fma_f32 v21, -v20, v20, v21
    v_max_f32_e64 v21, 0, v21
    v_cvt_pk_bf16_f32 v17, v20, v21
    v_lshlrev_b32 v20, 16, v17
    v_and_b32 v21, s97, v17
    v_add_f32_e64 v21, s27, v21
    v_cvt_pk_bf16_f32 v21, v21, v21
    v_and_b32 v21, s97, v21
    v_sqrt_f32 v21, v21
    s_nop 0
    v_cvt_pk_bf16_f32 v21, v21, v21
    v_and_b32 v21, s97, v21
    v_rcp_f32 v21, v21
    s_nop 0
    v_mul_f32 v20, v20, v21
    s_lshl_b32 s16, s3, 6
    v_lshl_add_u32 v17, v3, 2, s16
    ds_write_b32 v17, v21 offset:0
    ds_write_b32 v17, v20 offset:256
    s_waitcnt lgkmcnt(0)
    s_barrier
    s_setprio 0
    s_add_u32 s10, s9, 3
    s_and_b32 s10, s10, 7
    s_lshl_b32 s25, s10, 11
    s_add_u32 s25, s25, s24
    s_add_u32 m0, s23, 49152
    s_nop 0
    buffer_load_dwordx4 v5, s[68:71], s25 offen sc1 lds
    s_add_u32 m0, s23, 50176
    s_nop 0
    buffer_load_dwordx4 v6, s[68:71], s25 offen sc1 lds
    s_add_u32 m0, s23, 51200
    s_nop 0
    buffer_load_dwordx4 v7, s[68:71], s25 offen sc1 lds
    s_add_u32 s10, s9, 4
    s_and_b32 s10, s10, 7
    s_lshl_b32 s25, s10, 11
    s_add_u32 s25, s25, s24
    s_add_u32 m0, s23, 61440
    s_nop 0
    buffer_load_dwordx4 v5, s[68:71], s25 offen sc1 lds
    s_add_u32 m0, s23, 62464
    s_nop 0
    buffer_load_dwordx4 v6, s[68:71], s25 offen sc1 lds
    s_add_u32 m0, s23, 63488
    s_nop 0
    buffer_load_dwordx4 v7, s[68:71], s25 offen sc1 lds
    s_add_u32 s10, s9, 5
    s_and_b32 s10, s10, 7
    s_lshl_b32 s25, s10, 11
    s_add_u32 s25, s25, s24
    s_add_u32 m0, s23, 73728
    s_nop 0
    buffer_load_dwordx4 v5, s[68:71], s25 offen sc1 lds
    s_add_u32 m0, s23, 74752
    s_nop 0
    buffer_load_dwordx4 v6, s[68:71], s25 offen sc1 lds
    s_add_u32 m0, s23, 75776
    s_nop 0
    buffer_load_dwordx4 v7, s[68:71], s25 offen sc1 lds
    s_add_u32 s10, s9, 6
    s_and_b32 s10, s10, 7
    s_lshl_b32 s25, s10, 11
    s_add_u32 s25, s25, s24
    s_add_u32 m0, s23, 0
    s_nop 0
    buffer_load_dwordx4 v5, s[68:71], s25 offen sc1 lds
    s_add_u32 m0, s23, 1024
    s_nop 0
    buffer_load_dwordx4 v6, s[68:71], s25 offen sc1 lds
    s_add_u32 m0, s23, 2048
    s_nop 0
    buffer_load_dwordx4 v7, s[68:71], s25 offen sc1 lds
    v_lshrrev_b32 v12, 3, v1
    v_lshrrev_b32 v13, 2, v12
    v_lshlrev_b32 v13, 3, v13
    v_and_b32 v14, 3, v12
    v_add_u32 v13, v13, v14
    v_lshlrev_b32 v13, 12, v13
    v_lshrrev_b32 v12, 1, v12
    v_and_b32 v14, 7, v1
    v_xor_b32_e64 v12, v12, v14
    v_lshl_add_u32 v10, v12, 4, v13
    v_xor_b32_e64 v12, 4, v12
    v_lshl_add_u32 v11, v12, 4, v13
    v_add_u32 v11, 65536, v11
    s_lshl_b32 s16, s4, 18
    s_lshl_b32 s17, s7, 17
    s_add_u32 s16, s16, s17
    s_lshl_b32 s17, s8, 14
    s_add_u32 s50, s16, s17
    s_mov_b32 s52, s84
    s_and_b32 s53, s85, 0xffff
    s_mov_b32 s54, 8388608
    s_mov_b32 s55, 0x00020000
    s_and_b32 s51, s2, 7
    s_mul_i32 s51, s51, 0
    s_and_b32 s16, s2, 7
    s_xor_b32 s16, s16, 1
    s_lshl_b32 s16, s16, 20
    s_lshr_b32 s17, s2, 3
    s_lshl_b32 s17, s17, 15
    s_add_u32 s16, s16, s17
    s_lshl_b32 s17, s3, 7
    s_add_u32 s63, s16, s17
    v_lshrrev_b32 v78, 3, v1
    v_lshlrev_b32 v78, 12, v78
    v_lshl_add_u32 v78, v14, 4, v78
    s_barrier
    s_cmp_eq_u32 s3, 0
    s_cselect_b32 s34, s34, 0
    ds_read_b64 v[32:33], v18 offset:512
    ds_read_b64 v[34:35], v18 offset:1024
    s_waitcnt lgkmcnt(0)
    v_pk_add_f32 v[32:33], v[32:33], v[34:35]
    v_min_u32 v33, 0x7fffffff, v33
    buffer_store_dwordx2 v[32:33], v18, s[32:35], s45 offen sc1
    s_waitcnt vmcnt(16)
    s_barrier
    s_add_u32 s48, s51, 0
    s_and_b32 s48, s48, 0xfff
    s_add_u32 s48, s48, s50
    buffer_load_dwordx4 v[80:83], v10, s[52:55], s48 offen
    s_add_u32 s48, s51, 0
    s_and_b32 s48, s48, 0xfff
    s_add_u32 s48, s48, s50
    buffer_load_dwordx4 v[84:87], v11, s[52:55], s48 offen
    s_waitcnt vmcnt(15)
    s_barrier
    s_add_u32 s10, s9, 7
    s_and_b32 s10, s10, 7
    s_lshl_b32 s25, s10, 11
    s_add_u32 s25, s25, s24
    s_add_u32 m0, s23, 12288
    s_nop 0
    buffer_load_dwordx4 v5, s[68:71], s25 offen sc1 lds
    s_add_u32 m0, s23, 13312
    s_nop 0
    buffer_load_dwordx4 v6, s[68:71], s25 offen sc1 lds
    s_add_u32 m0, s23, 14336
    s_nop 0
    buffer_load_dwordx4 v7, s[68:71], s25 offen sc1 lds
    s_waitcnt vmcnt(15)
    s_barrier
    s_add_u32 s48, s51, 128
    s_and_b32 s48, s48, 0xfff
    s_add_u32 s48, s48, s50
    buffer_load_dwordx4 v[88:91], v10, s[52:55], s48 offen
    s_add_u32 s48, s51, 128
    s_and_b32 s48, s48, 0xfff
    s_add_u32 s48, s48, s50
    buffer_load_dwordx4 v[92:95], v11, s[52:55], s48 offen
    s_waitcnt vmcnt(14)
    s_barrier
    s_add_u32 s48, s51, 256
    s_and_b32 s48, s48, 0xfff
    s_add_u32 s48, s48, s50
    buffer_load_dwordx4 v[96:99], v10, s[52:55], s48 offen
    s_add_u32 s48, s51, 256
    s_and_b32 s48, s48, 0xfff
    s_add_u32 s48, s48, s50
    buffer_load_dwordx4 v[100:103], v11, s[52:55], s48 offen
    s_waitcnt vmcnt(13)
    s_barrier
    s_nop 0
    buffer_load_dwordx2 v[32:33], v18, s[32:35], s44 offen offset:0 sc1
    buffer_load_dwordx2 v[34:35], v18, s[32:35], s44 offen offset:512 sc1
    buffer_load_dwordx2 v[36:37], v18, s[32:35], s44 offen offset:1024 sc1
    buffer_load_dwordx2 v[38:39], v18, s[32:35], s44 offen offset:1536 sc1
    buffer_load_dwordx2 v[40:41], v18, s[32:35], s44 offen offset:2048 sc1
    buffer_load_dwordx2 v[42:43], v18, s[32:35], s44 offen offset:2560 sc1
    buffer_load_dwordx2 v[44:45], v18, s[32:35], s44 offen offset:3072 sc1
    buffer_load_dwordx2 v[46:47], v18, s[32:35], s44 offen offset:3584 sc1
    s_add_u32 s48, s51, 384
    s_and_b32 s48, s48, 0xfff
    s_add_u32 s48, s48, s50
    buffer_load_dwordx4 v[104:107], v10, s[52:55], s48 offen
    s_add_u32 s48, s51, 384
    s_and_b32 s48, s48, 0xfff
    s_add_u32 s48, s48, s50
    buffer_load_dwordx4 v[108:111], v11, s[52:55], s48 offen
    s_waitcnt vmcnt(20)
    s_barrier
    s_add_u32 s48, s51, 512
    s_and_b32 s48, s48, 0xfff
    s_add_u32 s48, s48, s50
    buffer_load_dwordx4 v[112:115], v10, s[52:55], s48 offen
    s_add_u32 s48, s51, 512
    s_and_b32 s48, s48, 0xfff
    s_add_u32 s48, s48, s50
    buffer_load_dwordx4 v[116:119], v11, s[52:55], s48 offen
    s_waitcnt vmcnt(16)
    s_barrier
    s_add_u32 s48, s51, 640
    s_and_b32 s48, s48, 0xfff
    s_add_u32 s48, s48, s50
    buffer_load_dwordx4 v[120:123], v10, s[52:55], s48 offen
    s_add_u32 s48, s51, 640
    s_and_b32 s48, s48, 0xfff
    s_add_u32 s48, s48, s50
    buffer_load_dwordx4 v[124:127], v11, s[52:55], s48 offen
    s_barrier
    s_cmp_lg_u32 s3, 0
    s_cbranch_scc1 kcd_lfin
    s_mov_b32 s47, 0
    s_waitcnt vmcnt(6)
kcd_poll:
    v_max3_u32 v48, v33, v35, v37
    v_max3_u32 v49, v39, v41, v43
    v_max3_u32 v48, v48, v45, v47
    v_max_u32 v48, v48, v49
    v_cmp_eq_u32 vcc, -1, v48
    s_nop 4
    s_cbranch_vccz kcd_got
    s_add_u32 s47, s47, 1
    s_cmp_ge_u32 s47, 1048576
    s_cbranch_scc1 kcd_got
    buffer_load_dwordx2 v[32:33], v18, s[32:35], s44 offen offset:0 sc1
    buffer_load_dwordx2 v[34:35], v18, s[32:35], s44 offen offset:512 sc1
    buffer_load_dwordx2 v[36:37], v18, s[32:35], s44 offen offset:1024 sc1
    buffer_load_dwordx2 v[38:39], v18, s[32:35], s44 offen offset:1536 sc1
    buffer_load_dwordx2 v[40:41], v18, s[32:35], s44 offen offset:2048 sc1
    buffer_load_dwordx2 v[42:43], v18, s[32:35], s44 offen offset:2560 sc1
    buffer_load_dwordx2 v[44:45], v18, s[32:35], s44 offen offset:3072 sc1
    buffer_load_dwordx2 v[46:47], v18, s[32:35], s44 offen offset:3584 sc1
    s_waitcnt vmcnt(0)
    s_branch kcd_poll
kcd_got:
    v_pk_add_f32 v[32:33], v[32:33], v[40:41]
    v_pk_add_f32 v[34:35], v[34:35], v[42:43]
    v_pk_add_f32 v[36:37], v[36:37], v[44:45]
    v_pk_add_f32 v[38:39], v[38:39], v[46:47]
    v_pk_add_f32 v[32:33], v[32:33], v[36:37]
    v_pk_add_f32 v[34:35], v[34:35], v[38:39]
    v_pk_add_f32 v[32:33], v[32:33], v[34:35]
    s_mov_b32 s46, 0x3abe82fa
    v_mul_f32 v32, s46, v32
    v_mul_f32_e64 v33, s46, v33
    v_fma_f32 v33, -v32, v32, v33
    v_max_f32_e64 v33, 0, v33
    v_cvt_pk_bf16_f32 v48, v32, v33
    v_lshlrev_b32 v32, 16, v48
    v_and_b32 v33, s97, v48
    v_add_f32_e64 v33, s27, v33
    v_cvt_pk_bf16_f32 v33, v33, v33
    v_and_b32 v33, s97, v33
    v_sqrt_f32 v33, v33
    s_nop 0
    v_cvt_pk_bf16_f32 v33, v33, v33
    v_and_b32 v33, s97, v33
    v_rcp_f32 v33, v33
    s_nop 0
    v_mul_f32 v32, -v32, v33
    v_lshlrev_b32_e64 v17, 2, v1
    ds_write_b32 v17, v33 offset:1536
    ds_write_b32 v17, v32 offset:1792
    s_waitcnt lgkmcnt(0)
kcd_lfin:
    s_barrier
    s_mul_i32 s16, s8, 196608
    v_add_u32_e64 v5, s16, v4
    v_add_u32 v6, 0x10000, v5
    v_add_u32 v7, 0x20000, v5
    s_lshl_b32 s16, s41, 16
    s_add_u32 s16, s16, 11206656
    s_lshl_b32 s17, s43, 16
    s_add_u32 s56, s36, s16
    s_addc_u32 s57, s37, 0
    s_and_b32 s57, s57, 0xffff
    s_mov_b32 s58, s17
    s_mov_b32 s59, 0x00020000
    s_lshl_b32 s60, s3, 11
    s_add_u32 s60, s60, 4096
    s_mul_i32 s61, s3, 3072
    s_add_u32 s61, s61, 12288
    v_add_u32_e64 v12, s60, v4
    v_add_u32 v13, 61440, v12
    v_add_u32 v14, 122880, v12
    s_waitcnt vmcnt(0)
    s_nop 0
    ds_write_b128 v12, v[80:83] offset:0
    ds_write_b128 v12, v[84:87] offset:1024
    ds_write_b128 v12, v[88:91] offset:20480
    ds_write_b128 v12, v[92:95] offset:21504
    ds_write_b128 v12, v[96:99] offset:40960
    ds_write_b128 v12, v[100:103] offset:41984
    ds_write_b128 v13, v[104:107] offset:0
    ds_write_b128 v13, v[108:111] offset:1024
    ds_write_b128 v13, v[112:115] offset:20480
    ds_write_b128 v13, v[116:119] offset:21504
    ds_write_b128 v13, v[120:123] offset:40960
    ds_write_b128 v13, v[124:127] offset:41984
    s_barrier
    s_cmp_lg_u32 s3, 0
    s_cbranch_scc1 kcd_g2_x
    s_mov_b32 s62, 16384
    s_mov_b64 exec, 0xff
    buffer_atomic_add v74, v72, s[76:79], s62 offen sc1
    s_mov_b64 exec, -1
    s_mov_b32 s47, 0
    s_sleep 16
kcd_g2_p:
    buffer_load_dword v75, v73, s[76:79], s62 offen sc1
    s_add_u32 s47, s47, 1
    s_waitcnt vmcnt(0)
    v_cmp_gt_u32 vcc, 16, v75
    s_nop 4
    s_cbranch_vccz kcd_g2_x
    s_sleep 4
    s_cmp_lt_u32 s47, 1048576
    s_cbranch_scc1 kcd_g2_p
kcd_g2_x:
    s_barrier
    s_add_u32 s48, s51, 0
    s_and_b32 s48, s48, 0xfff
    s_lshl_b32 s25, s48, 4
    s_add_u32 s25, s25, s24
    s_add_u32 m0, s61, 0
    s_nop 0
    buffer_load_dwordx4 v5, s[56:59], s25 offen sc1 lds
    s_add_u32 m0, s61, 1024
    s_nop 0
    buffer_load_dwordx4 v6, s[56:59], s25 offen sc1 lds
    s_add_u32 m0, s61, 2048
    s_nop 0
    buffer_load_dwordx4 v7, s[56:59], s25 offen sc1 lds
    s_add_u32 s48, s51, 128
    s_and_b32 s48, s48, 0xfff
    s_lshl_b32 s25, s48, 4
    s_add_u32 s25, s25, s24
    s_add_u32 m0, s61, 20480
    s_nop 0
    buffer_load_dwordx4 v5, s[56:59], s25 offen sc1 lds
    s_add_u32 m0, s61, 21504
    s_nop 0
    buffer_load_dwordx4 v6, s[56:59], s25 offen sc1 lds
    s_add_u32 m0, s61, 22528
    s_nop 0
    buffer_load_dwordx4 v7, s[56:59], s25 offen sc1 lds
    s_add_u32 s48, s51, 256
    s_and_b32 s48, s48, 0xfff
    s_lshl_b32 s25, s48, 4
    s_add_u32 s25, s25, s24
    s_add_u32 m0, s61, 40960
    s_nop 0
    buffer_load_dwordx4 v5, s[56:59], s25 offen sc1 lds
    s_add_u32 m0, s61, 41984
    s_nop 0
    buffer_load_dwordx4 v6, s[56:59], s25 offen sc1 lds
    s_add_u32 m0, s61, 43008
    s_nop 0
    buffer_load_dwordx4 v7, s[56:59], s25 offen sc1 lds
    s_add_u32 s48, s51, 384
    s_and_b32 s48, s48, 0xfff
    s_lshl_b32 s25, s48, 4
    s_add_u32 s25, s25, s24
    s_add_u32 m0, s61, 61440
    s_nop 0
    buffer_load_dwordx4 v5, s[56:59], s25 offen sc1 lds
    s_add_u32 m0, s61, 62464
    s_nop 0
    buffer_load_dwordx4 v6, s[56:59], s25 offen sc1 lds
    s_add_u32 m0, s61, 63488
    s_nop 0
    buffer_load_dwordx4 v7, s[56:59], s25 offen sc1 lds
    s_add_u32 s48, s51, 512
    s_and_b32 s48, s48, 0xfff
    s_lshl_b32 s25, s48, 4
    s_add_u32 s25, s25, s24
    s_add_u32 m0, s61, 81920
    s_nop 0
    buffer_load_dwordx4 v5, s[56:59], s25 offen sc1 lds
    s_add_u32 m0, s61, 82944
    s_nop 0
    buffer_load_dwordx4 v6, s[56:59], s25 offen sc1 lds
    s_add_u32 m0, s61, 83968
    s_nop 0
    buffer_load_dwordx4 v7, s[56:59], s25 offen sc1 lds
    s_add_u32 s48, s51, 640
    s_and_b32 s48, s48, 0xfff
    s_lshl_b32 s25, s48, 4
    s_add_u32 s25, s25, s24
    s_add_u32 m0, s61, 102400
    s_nop 0
    buffer_load_dwordx4 v5, s[56:59], s25 offen sc1 lds
    s_add_u32 m0, s61, 103424
    s_nop 0
    buffer_load_dwordx4 v6, s[56:59], s25 offen sc1 lds
    s_add_u32 m0, s61, 104448
    s_nop 0
    buffer_load_dwordx4 v7, s[56:59], s25 offen sc1 lds
    s_mul_i32 s16, s5, 90112
    s_add_u32 s16, s16, 6684672
    s_add_u32 s64, s36, s16
    s_addc_u32 s65, s37, 0
    s_and_b32 s65, s65, 0xffff
    s_mov_b32 s66, 90112
    s_mov_b32 s67, 0x00020000
    s_mul_i32 s63, s3, 5120
    v_add_u32_e64 v15, s63, v4
    s_add_u32 s63, s63, 4096
    s_lshl_b32 s16, s4, 2
    s_add_u32 s16, s16, s3
    s_mul_i32 s16, s16, 22528
    s_add_u32 s16, s16, 14680064
    s_add_u32 s68, s36, s16
    s_addc_u32 s69, s37, 0
    s_and_b32 s69, s69, 0xffff
    s_mov_b32 s70, 22528
    s_mov_b32 s71, 0x00020000
    s_lshl_b32 s16, s4, 7
    s_add_u32 s16, s16, 0x8000
    v_mov_b32 v21, s16
    s_mul_i32 s26, s3, 22528
    s_add_u32 s26, s26, 4096
    s_waitcnt vmcnt(15) lgkmcnt(0)
    s_barrier
    s_waitcnt vmcnt(12) lgkmcnt(4)
    s_barrier
    s_add_u32 s48, s51, 768
    s_and_b32 s48, s48, 0xfff
    s_add_u32 m0, s60, 122880
    s_add_u32 s25, s50, s48
    buffer_load_dwordx4 v10, s[52:55], s25 offen lds
    s_add_u32 m0, s60, 123904
    s_add_u32 s25, s50, s48
    buffer_load_dwordx4 v11, s[52:55], s25 offen lds
    s_lshl_b32 s25, s48, 4
    s_add_u32 s25, s25, s24
    s_add_u32 m0, s61, 122880
    s_nop 0
    buffer_load_dwordx4 v5, s[56:59], s25 offen sc1 lds
    s_add_u32 m0, s61, 123904
    s_nop 0
    buffer_load_dwordx4 v6, s[56:59], s25 offen sc1 lds
    s_add_u32 m0, s61, 124928
    s_nop 0
    buffer_load_dwordx4 v7, s[56:59], s25 offen sc1 lds
    s_waitcnt vmcnt(14) lgkmcnt(4)
    s_barrier
    s_add_u32 s48, s51, 896
    s_and_b32 s48, s48, 0xfff
    s_add_u32 m0, s60, 0
    s_add_u32 s25, s50, s48
    buffer_load_dwordx4 v10, s[52:55], s25 offen lds
    s_add_u32 m0, s60, 1024
    s_add_u32 s25, s50, s48
    buffer_load_dwordx4 v11, s[52:55], s25 offen lds
    s_lshl_b32 s25, s48, 4
    s_add_u32 s25, s25, s24
    s_add_u32 m0, s61, 0
    s_nop 0
    buffer_load_dwordx4 v5, s[56:59], s25 offen sc1 lds
    s_add_u32 m0, s61, 1024
    s_nop 0
    buffer_load_dwordx4 v6, s[56:59], s25 offen sc1 lds
    s_add_u32 m0, s61, 2048
    s_nop 0
    buffer_load_dwordx4 v7, s[56:59], s25 offen sc1 lds
    s_waitcnt vmcnt(16) lgkmcnt(0)
    s_barrier
    s_add_u32 s48, s51, 1024
    s_and_b32 s48, s48, 0xfff
    s_add_u32 m0, s60, 20480
    s_add_u32 s25, s50, s48
    buffer_load_dwordx4 v10, s[52:55], s25 offen lds
    s_add_u32 m0, s60, 21504
    s_add_u32 s25, s50, s48
    buffer_load_dwordx4 v11, s[52:55], s25 offen lds
    s_lshl_b32 s25, s48, 4
    s_add_u32 s25, s25, s24
    s_add_u32 m0, s61, 20480
    s_nop 0
    buffer_load_dwordx4 v5, s[56:59], s25 offen sc1 lds
    s_add_u32 m0, s61, 21504
    s_nop 0
    buffer_load_dwordx4 v6, s[56:59], s25 offen sc1 lds
    s_add_u32 m0, s61, 22528
    s_nop 0
    buffer_load_dwordx4 v7, s[56:59], s25 offen sc1 lds
    s_waitcnt vmcnt(18) lgkmcnt(0)
    s_barrier
    s_add_u32 s48, s51, 1152
    s_and_b32 s48, s48, 0xfff
    s_add_u32 m0, s60, 40960
    s_add_u32 s25, s50, s48
    buffer_load_dwordx4 v10, s[52:55], s25 offen lds
    s_add_u32 m0, s60, 41984
    s_add_u32 s25, s50, s48
    buffer_load_dwordx4 v11, s[52:55], s25 offen lds
    s_lshl_b32 s25, s48, 4
    s_add_u32 s25, s25, s24
    s_add_u32 m0, s61, 40960
    s_nop 0
    buffer_load_dwordx4 v5, s[56:59], s25 offen sc1 lds
    s_add_u32 m0, s61, 41984
    s_nop 0
    buffer_load_dwordx4 v6, s[56:59], s25 offen sc1 lds
    s_add_u32 m0, s61, 43008
    s_nop 0
    buffer_load_dwordx4 v7, s[56:59], s25 offen sc1 lds
    s_waitcnt vmcnt(20) lgkmcnt(0)
    s_barrier
    s_add_u32 s48, s51, 1280
    s_and_b32 s48, s48, 0xfff
    s_add_u32 m0, s60, 61440
    s_add_u32 s25, s50, s48
    buffer_load_dwordx4 v10, s[52:55], s25 offen lds
    s_add_u32 m0, s60, 62464
    s_add_u32 s25, s50, s48
    buffer_load_dwordx4 v11, s[52:55], s25 offen lds
    s_lshl_b32 s25, s48, 4
    s_add_u32 s25, s25, s24
    s_add_u32 m0, s61, 61440
    s_nop 0
    buffer_load_dwordx4 v5, s[56:59], s25 offen sc1 lds
    s_add_u32 m0, s61, 62464
    s_nop 0
    buffer_load_dwordx4 v6, s[56:59], s25 offen sc1 lds
    s_add_u32 m0, s61, 63488
    s_nop 0
    buffer_load_dwordx4 v7, s[56:59], s25 offen sc1 lds
    s_waitcnt vmcnt(20) lgkmcnt(0)
    s_barrier
    s_add_u32 s48, s51, 1408
    s_and_b32 s48, s48, 0xfff
    s_add_u32 m0, s60, 81920
    s_add_u32 s25, s50, s48
    buffer_load_dwordx4 v10, s[52:55], s25 offen lds
    s_add_u32 m0, s60, 82944
    s_add_u32 s25, s50, s48
    buffer_load_dwordx4 v11, s[52:55], s25 offen lds
    s_lshl_b32 s25, s48, 4
    s_add_u32 s25, s25, s24
    s_add_u32 m0, s61, 81920
    s_nop 0
    buffer_load_dwordx4 v5, s[56:59], s25 offen sc1 lds
    s_add_u32 m0, s61, 82944
    s_nop 0
    buffer_load_dwordx4 v6, s[56:59], s25 offen sc1 lds
    s_add_u32 m0, s61, 83968
    s_nop 0
    buffer_load_dwordx4 v7, s[56:59], s25 offen sc1 lds
    s_waitcnt vmcnt(20) lgkmcnt(0)
    s_barrier
    s_add_u32 s48, s51, 1536
    s_and_b32 s48, s48, 0xfff
    s_add_u32 m0, s60, 102400
    s_add_u32 s25, s50, s48
    buffer_load_dwordx4 v10, s[52:55], s25 offen lds
    s_add_u32 m0, s60, 103424
    s_add_u32 s25, s50, s48
    buffer_load_dwordx4 v11, s[52:55], s25 offen lds
    s_lshl_b32 s25, s48, 4
    s_add_u32 s25, s25, s24
    s_add_u32 m0, s61, 102400
    s_nop 0
    buffer_load_dwordx4 v5, s[56:59], s25 offen sc1 lds
    s_add_u32 m0, s61, 103424
    s_nop 0
    buffer_load_dwordx4 v6, s[56:59], s25 offen sc1 lds
    s_add_u32 m0, s61, 104448
    s_nop 0
    buffer_load_dwordx4 v7, s[56:59], s25 offen sc1 lds
    s_waitcnt vmcnt(20) lgkmcnt(0)
    s_barrier
    s_add_u32 s48, s51, 1664
    s_and_b32 s48, s48, 0xfff
    s_add_u32 m0, s60, 122880
    s_add_u32 s25, s50, s48
    buffer_load_dwordx4 v10, s[52:55], s25 offen lds
    s_add_u32 m0, s60, 123904
    s_add_u32 s25, s50, s48
    buffer_load_dwordx4 v11, s[52:55], s25 offen lds
    s_lshl_b32 s25, s48, 4
    s_add_u32 s25, s25, s24
    s_add_u32 m0, s61, 122880
    s_nop 0
    buffer_load_dwordx4 v5, s[56:59], s25 offen sc1 lds
    s_add_u32 m0, s61, 123904
    s_nop 0
    buffer_load_dwordx4 v6, s[56:59], s25 offen sc1 lds
    s_add_u32 m0, s61, 124928
    s_nop 0
    buffer_load_dwordx4 v7, s[56:59], s25 offen sc1 lds
    s_waitcnt vmcnt(20) lgkmcnt(0)
    s_barrier
    s_add_u32 s48, s51, 1792
    s_and_b32 s48, s48, 0xfff
    s_add_u32 m0, s60, 0
    s_add_u32 s25, s50, s48
    buffer_load_dwordx4 v10, s[52:55], s25 offen lds
    s_add_u32 m0, s60, 1024
    s_add_u32 s25, s50, s48
    buffer_load_dwordx4 v11, s[52:55], s25 offen lds
    s_lshl_b32 s25, s48, 4
    s_add_u32 s25, s25, s24
    s_add_u32 m0, s61, 0
    s_nop 0
    buffer_load_dwordx4 v5, s[56:59], s25 offen sc1 lds
    s_add_u32 m0, s61, 1024
    s_nop 0
    buffer_load_dwordx4 v6, s[56:59], s25 offen sc1 lds
    s_add_u32 m0, s61, 2048
    s_nop 0
    buffer_load_dwordx4 v7, s[56:59], s25 offen sc1 lds
    s_waitcnt vmcnt(20) lgkmcnt(0)
    s_barrier
    s_add_u32 s48, s51, 1920
    s_and_b32 s48, s48, 0xfff
    s_add_u32 m0, s60, 20480
    s_add_u32 s25, s50, s48
    buffer_load_dwordx4 v10, s[52:55], s25 offen lds
    s_add_u32 m0, s60, 21504
    s_add_u32 s25, s50, s48
    buffer_load_dwordx4 v11, s[52:55], s25 offen lds
    s_lshl_b32 s25, s48, 4
    s_add_u32 s25, s25, s24
    s_add_u32 m0, s61, 20480
    s_nop 0
    buffer_load_dwordx4 v5, s[56:59], s25 offen sc1 lds
    s_add_u32 m0, s61, 21504
    s_nop 0
    buffer_load_dwordx4 v6, s[56:59], s25 offen sc1 lds
    s_add_u32 m0, s61, 22528
    s_nop 0
    buffer_load_dwordx4 v7, s[56:59], s25 offen sc1 lds
    s_waitcnt vmcnt(20) lgkmcnt(0)
    s_barrier
    s_add_u32 s48, s51, 2048
    s_and_b32 s48, s48, 0xfff
    s_add_u32 m0, s60, 40960
    s_add_u32 s25, s50, s48
    buffer_load_dwordx4 v10, s[52:55], s25 offen lds
    s_add_u32 m0, s60, 41984
    s_add_u32 s25, s50, s48
    buffer_load_dwordx4 v11, s[52:55], s25 offen lds
    s_lshl_b32 s25, s48, 4
    s_add_u32 s25, s25, s24
    s_add_u32 m0, s61, 40960
    s_nop 0
    buffer_load_dwordx4 v5, s[56:59], s25 offen sc1 lds
    s_add_u32 m0, s61, 41984
    s_nop 0
    buffer_load_dwordx4 v6, s[56:59], s25 offen sc1 lds
    s_add_u32 m0, s61, 43008
    s_nop 0
    buffer_load_dwordx4 v7, s[56:59], s25 offen sc1 lds
    s_waitcnt vmcnt(20) lgkmcnt(0)
    s_barrier
    s_add_u32 s48, s51, 2176
    s_and_b32 s48, s48, 0xfff
    s_add_u32 m0, s60, 61440
    s_add_u32 s25, s50, s48
    buffer_load_dwordx4 v10, s[52:55], s25 offen lds
    s_add_u32 m0, s60, 62464
    s_add_u32 s25, s50, s48
    buffer_load_dwordx4 v11, s[52:55], s25 offen lds
    s_lshl_b32 s25, s48, 4
    s_add_u32 s25, s25, s24
    s_add_u32 m0, s61, 61440
    s_nop 0
    buffer_load_dwordx4 v5, s[56:59], s25 offen sc1 lds
    s_add_u32 m0, s61, 62464
    s_nop 0
    buffer_load_dwordx4 v6, s[56:59], s25 offen sc1 lds
    s_add_u32 m0, s61, 63488
    s_nop 0
    buffer_load_dwordx4 v7, s[56:59], s25 offen sc1 lds
    s_waitcnt vmcnt(20) lgkmcnt(0)
    s_barrier
    s_add_u32 s48, s51, 2304
    s_and_b32 s48, s48, 0xfff
    s_add_u32 m0, s60, 81920
    s_add_u32 s25, s50, s48
    buffer_load_dwordx4 v10, s[52:55], s25 offen lds
    s_add_u32 m0, s60, 82944
    s_add_u32 s25, s50, s48
    buffer_load_dwordx4 v11, s[52:55], s25 offen lds
    s_lshl_b32 s25, s48, 4
    s_add_u32 s25, s25, s24
    s_add_u32 m0, s61, 81920
    s_nop 0
    buffer_load_dwordx4 v5, s[56:59], s25 offen sc1 lds
    s_add_u32 m0, s61, 82944
    s_nop 0
    buffer_load_dwordx4 v6, s[56:59], s25 offen sc1 lds
    s_add_u32 m0, s61, 83968
    s_nop 0
    buffer_load_dwordx4 v7, s[56:59], s25 offen sc1 lds
    s_waitcnt vmcnt(20) lgkmcnt(0)
    s_barrier
    s_add_u32 s48, s51, 2432
    s_and_b32 s48, s48, 0xfff
    s_add_u32 m0, s60, 102400
    s_add_u32 s25, s50, s48
    buffer_load_dwordx4 v10, s[52:55], s25 offen lds
    s_add_u32 m0, s60, 103424
    s_add_u32 s25, s50, s48
    buffer_load_dwordx4 v11, s[52:55], s25 offen lds
    s_lshl_b32 s25, s48, 4
    s_add_u32 s25, s25, s24
    s_add_u32 m0, s61, 102400
    s_nop 0
    buffer_load_dwordx4 v5, s[56:59], s25 offen sc1 lds
    s_add_u32 m0, s61, 103424
    s_nop 0
    buffer_load_dwordx4 v6, s[56:59], s25 offen sc1 lds
    s_add_u32 m0, s61, 104448
    s_nop 0
    buffer_load_dwordx4 v7, s[56:59], s25 offen sc1 lds
    s_waitcnt vmcnt(20) lgkmcnt(0)
    s_barrier
    s_add_u32 s48, s51, 2560
    s_and_b32 s48, s48, 0xfff
    s_add_u32 m0, s60, 122880
    s_add_u32 s25, s50, s48
    buffer_load_dwordx4 v10, s[52:55], s25 offen lds
    s_add_u32 m0, s60, 123904
    s_add_u32 s25, s50, s48
    buffer_load_dwordx4 v11, s[52:55], s25 offen lds
    s_lshl_b32 s25, s48, 4
    s_add_u32 s25, s25, s24
    s_add_u32 m0, s61, 122880
    s_nop 0
    buffer_load_dwordx4 v5, s[56:59], s25 offen sc1 lds
    s_add_u32 m0, s61, 123904
    s_nop 0
    buffer_load_dwordx4 v6, s[56:59], s25 offen sc1 lds
    s_add_u32 m0, s61, 124928
    s_nop 0
    buffer_load_dwordx4 v7, s[56:59], s25 offen sc1 lds
    s_waitcnt vmcnt(20) lgkmcnt(0)
    s_barrier
    s_add_u32 s48, s51, 2688
    s_and_b32 s48, s48, 0xfff
    s_add_u32 m0, s60, 0
    s_add_u32 s25, s50, s48
    buffer_load_dwordx4 v10, s[52:55], s25 offen lds
    s_add_u32 m0, s60, 1024
    s_add_u32 s25, s50, s48
    buffer_load_dwordx4 v11, s[52:55], s25 offen lds
    s_lshl_b32 s25, s48, 4
    s_add_u32 s25, s25, s24
    s_add_u32 m0, s61, 0
    s_nop 0
    buffer_load_dwordx4 v5, s[56:59], s25 offen sc1 lds
    s_add_u32 m0, s61, 1024
    s_nop 0
    buffer_load_dwordx4 v6, s[56:59], s25 offen sc1 lds
    s_add_u32 m0, s61, 2048
    s_nop 0
    buffer_load_dwordx4 v7, s[56:59], s25 offen sc1 lds
    s_waitcnt vmcnt(20) lgkmcnt(0)
    s_barrier
    s_add_u32 s48, s51, 2816
    s_and_b32 s48, s48, 0xfff
    s_add_u32 m0, s60, 20480
    s_add_u32 s25, s50, s48
    buffer_load_dwordx4 v10, s[52:55], s25 offen lds
    s_add_u32 m0, s60, 21504
    s_add_u32 s25, s50, s48
    buffer_load_dwordx4 v11, s[52:55], s25 offen lds
    s_lshl_b32 s25, s48, 4
    s_add_u32 s25, s25, s24
    s_add_u32 m0, s61, 20480
    s_nop 0
    buffer_load_dwordx4 v5, s[56:59], s25 offen sc1 lds
    s_add_u32 m0, s61, 21504
    s_nop 0
    buffer_load_dwordx4 v6, s[56:59], s25 offen sc1 lds
    s_add_u32 m0, s61, 22528
    s_nop 0
    buffer_load_dwordx4 v7, s[56:59], s25 offen sc1 lds
    s_waitcnt vmcnt(20) lgkmcnt(0)
    s_barrier
    s_add_u32 s48, s51, 2944
    s_and_b32 s48, s48, 0xfff
    s_add_u32 m0, s60, 40960
    s_add_u32 s25, s50, s48
    buffer_load_dwordx4 v10, s[52:55], s25 offen lds
    s_add_u32 m0, s60, 41984
    s_add_u32 s25, s50, s48
    buffer_load_dwordx4 v11, s[52:55], s25 offen lds
    s_lshl_b32 s25, s48, 4
    s_add_u32 s25, s25, s24
    s_add_u32 m0, s61, 40960
    s_nop 0
    buffer_load_dwordx4 v5, s[56:59], s25 offen sc1 lds
    s_add_u32 m0, s61, 41984
    s_nop 0
    buffer_load_dwordx4 v6, s[56:59], s25 offen sc1 lds
    s_add_u32 m0, s61, 43008
    s_nop 0
    buffer_load_dwordx4 v7, s[56:59], s25 offen sc1 lds
    s_waitcnt vmcnt(20) lgkmcnt(0)
    s_barrier
    s_add_u32 s48, s51, 3072
    s_and_b32 s48, s48, 0xfff
    s_add_u32 m0, s60, 61440
    s_add_u32 s25, s50, s48
    buffer_load_dwordx4 v10, s[52:55], s25 offen lds
    s_add_u32 m0, s60, 62464
    s_add_u32 s25, s50, s48
    buffer_load_dwordx4 v11, s[52:55], s25 offen lds
    s_lshl_b32 s25, s48, 4
    s_add_u32 s25, s25, s24
    s_add_u32 m0, s61, 61440
    s_nop 0
    buffer_load_dwordx4 v5, s[56:59], s25 offen sc1 lds
    s_add_u32 m0, s61, 62464
    s_nop 0
    buffer_load_dwordx4 v6, s[56:59], s25 offen sc1 lds
    s_add_u32 m0, s61, 63488
    s_nop 0
    buffer_load_dwordx4 v7, s[56:59], s25 offen sc1 lds
    s_waitcnt vmcnt(20) lgkmcnt(0)
    s_barrier
    s_add_u32 s48, s51, 3200
    s_and_b32 s48, s48, 0xfff
    s_add_u32 m0, s60, 81920
    s_add_u32 s25, s50, s48
    buffer_load_dwordx4 v10, s[52:55], s25 offen lds
    s_add_u32 m0, s60, 82944
    s_add_u32 s25, s50, s48
    buffer_load_dwordx4 v11, s[52:55], s25 offen lds
    s_lshl_b32 s25, s48, 4
    s_add_u32 s25, s25, s24
    s_add_u32 m0, s61, 81920
    s_nop 0
    buffer_load_dwordx4 v5, s[56:59], s25 offen sc1 lds
    s_add_u32 m0, s61, 82944
    s_nop 0
    buffer_load_dwordx4 v6, s[56:59], s25 offen sc1 lds
    s_add_u32 m0, s61, 83968
    s_nop 0
    buffer_load_dwordx4 v7, s[56:59], s25 offen sc1 lds
    s_waitcnt vmcnt(20) lgkmcnt(0)
    s_barrier
    s_add_u32 s48, s51, 3328
    s_and_b32 s48, s48, 0xfff
    s_add_u32 m0, s60, 102400
    s_add_u32 s25, s50, s48
    buffer_load_dwordx4 v10, s[52:55], s25 offen lds
    s_add_u32 m0, s60, 103424
    s_add_u32 s25, s50, s48
    buffer_load_dwordx4 v11, s[52:55], s25 offen lds
    s_lshl_b32 s25, s48, 4
    s_add_u32 s25, s25, s24
    s_add_u32 m0, s61, 102400
    s_nop 0
    buffer_load_dwordx4 v5, s[56:59], s25 offen sc1 lds
    s_add_u32 m0, s61, 103424
    s_nop 0
    buffer_load_dwordx4 v6, s[56:59], s25 offen sc1 lds
    s_add_u32 m0, s61, 104448
    s_nop 0
    buffer_load_dwordx4 v7, s[56:59], s25 offen sc1 lds
    s_waitcnt vmcnt(20) lgkmcnt(0)
    s_barrier
    s_add_u32 s48, s51, 3456
    s_and_b32 s48, s48, 0xfff
    s_add_u32 m0, s60, 122880
    s_add_u32 s25, s50, s48
    buffer_load_dwordx4 v10, s[52:55], s25 offen lds
    s_add_u32 m0, s60, 123904
    s_add_u32 s25, s50, s48
    buffer_load_dwordx4 v11, s[52:55], s25 offen lds
    s_lshl_b32 s25, s48, 4
    s_add_u32 s25, s25, s24
    s_add_u32 m0, s61, 122880
    s_nop 0
    buffer_load_dwordx4 v5, s[56:59], s25 offen sc1 lds
    s_add_u32 m0, s61, 123904
    s_nop 0
    buffer_load_dwordx4 v6, s[56:59], s25 offen sc1 lds
    s_add_u32 m0, s61, 124928
    s_nop 0
    buffer_load_dwordx4 v7, s[56:59], s25 offen sc1 lds
    s_waitcnt vmcnt(20) lgkmcnt(0)
    s_barrier
    s_add_u32 s48, s51, 3584
    s_and_b32 s48, s48, 0xfff
    s_add_u32 m0, s60, 0
    s_add_u32 s25, s50, s48
    buffer_load_dwordx4 v10, s[52:55], s25 offen lds
    s_add_u32 m0, s60, 1024
    s_add_u32 s25, s50, s48
    buffer_load_dwordx4 v11, s[52:55], s25 offen lds
    s_lshl_b32 s25, s48, 4
    s_add_u32 s25, s25, s24
    s_add_u32 m0, s61, 0
    s_nop 0
    buffer_load_dwordx4 v5, s[56:59], s25 offen sc1 lds
    s_add_u32 m0, s61, 1024
    s_nop 0
    buffer_load_dwordx4 v6, s[56:59], s25 offen sc1 lds
    s_add_u32 m0, s61, 2048
    s_nop 0
    buffer_load_dwordx4 v7, s[56:59], s25 offen sc1 lds
    s_waitcnt vmcnt(20) lgkmcnt(0)
    s_barrier
    s_add_u32 s48, s51, 3712
    s_and_b32 s48, s48, 0xfff
    s_add_u32 m0, s60, 20480
    s_add_u32 s25, s50, s48
    buffer_load_dwordx4 v10, s[52:55], s25 offen lds
    s_add_u32 m0, s60, 21504
    s_add_u32 s25, s50, s48
    buffer_load_dwordx4 v11, s[52:55], s25 offen lds
    s_lshl_b32 s25, s48, 4
    s_add_u32 s25, s25, s24
    s_add_u32 m0, s61, 20480
    s_nop 0
    buffer_load_dwordx4 v5, s[56:59], s25 offen sc1 lds
    s_add_u32 m0, s61, 21504
    s_nop 0
    buffer_load_dwordx4 v6, s[56:59], s25 offen sc1 lds
    s_add_u32 m0, s61, 22528
    s_nop 0
    buffer_load_dwordx4 v7, s[56:59], s25 offen sc1 lds
    s_waitcnt vmcnt(20) lgkmcnt(0)
    s_barrier
    s_add_u32 s48, s51, 3840
    s_and_b32 s48, s48, 0xfff
    s_add_u32 m0, s60, 40960
    s_add_u32 s25, s50, s48
    buffer_load_dwordx4 v10, s[52:55], s25 offen lds
    s_add_u32 m0, s60, 41984
    s_add_u32 s25, s50, s48
    buffer_load_dwordx4 v11, s[52:55], s25 offen lds
    s_lshl_b32 s25, s48, 4
    s_add_u32 s25, s25, s24
    s_add_u32 m0, s61, 40960
    s_nop 0
    buffer_load_dwordx4 v5, s[56:59], s25 offen sc1 lds
    s_add_u32 m0, s61, 41984
    s_nop 0
    buffer_load_dwordx4 v6, s[56:59], s25 offen sc1 lds
    s_add_u32 m0, s61, 43008
    s_nop 0
    buffer_load_dwordx4 v7, s[56:59], s25 offen sc1 lds
    s_waitcnt vmcnt(20) lgkmcnt(0)
    s_barrier
    s_add_u32 s48, s51, 3968
    s_and_b32 s48, s48, 0xfff
    s_add_u32 m0, s60, 61440
    s_add_u32 s25, s50, s48
    buffer_load_dwordx4 v10, s[52:55], s25 offen lds
    s_add_u32 m0, s60, 62464
    s_add_u32 s25, s50, s48
    buffer_load_dwordx4 v11, s[52:55], s25 offen lds
    s_lshl_b32 s25, s48, 4
    s_add_u32 s25, s25, s24
    s_add_u32 m0, s61, 61440
    s_nop 0
    buffer_load_dwordx4 v5, s[56:59], s25 offen sc1 lds
    s_add_u32 m0, s61, 62464
    s_nop 0
    buffer_load_dwordx4 v6, s[56:59], s25 offen sc1 lds
    s_add_u32 m0, s61, 63488
    s_nop 0
    buffer_load_dwordx4 v7, s[56:59], s25 offen sc1 lds
    s_waitcnt vmcnt(20) lgkmcnt(0)
    s_barrier
    s_add_u32 m0, s63, 81920
    v_add_u32_e64 v22, 0, v15
    buffer_load_dwordx4 v22, s[64:67], 0 offen offset:0 sc1 lds
    buffer_load_dwordx4 v22, s[64:67], 0 offen offset:1024 sc1 lds
    buffer_load_dwordx4 v22, s[64:67], 0 offen offset:2048 sc1 lds
    buffer_load_dwordx4 v22, s[64:67], 0 offen offset:3072 sc1 lds
    s_add_u32 m0, s63, 86016
    v_add_u32 v22, 4096, v15
    buffer_load_dwordx4 v22, s[64:67], 0 offen offset:0 sc1 lds
    s_waitcnt vmcnt(20) lgkmcnt(0)
    s_barrier
    s_add_u32 m0, s63, 102400
    v_add_u32 v22, 20480, v15
    buffer_load_dwordx4 v22, s[64:67], 0 offen offset:0 sc1 lds
    buffer_load_dwordx4 v22, s[64:67], 0 offen offset:1024 sc1 lds
    buffer_load_dwordx4 v22, s[64:67], 0 offen offset:2048 sc1 lds
    buffer_load_dwordx4 v22, s[64:67], 0 offen offset:3072 sc1 lds
    s_add_u32 m0, s63, 106496
    v_add_u32 v22, 24576, v15
    buffer_load_dwordx4 v22, s[64:67], 0 offen offset:0 sc1 lds
    s_waitcnt vmcnt(20) lgkmcnt(0)
    s_barrier
    s_add_u32 m0, s63, 122880
    v_add_u32 v22, 40960, v15
    buffer_load_dwordx4 v22, s[64:67], 0 offen offset:0 sc1 lds
    buffer_load_dwordx4 v22, s[64:67], 0 offen offset:1024 sc1 lds
    buffer_load_dwordx4 v22, s[64:67], 0 offen offset:2048 sc1 lds
    buffer_load_dwordx4 v22, s[64:67], 0 offen offset:3072 sc1 lds
    s_add_u32 m0, s63, 126976
    v_add_u32 v22, 45056, v15
    buffer_load_dwordx4 v22, s[64:67], 0 offen offset:0 sc1 lds
    s_waitcnt vmcnt(20) lgkmcnt(0)
    s_barrier
    s_add_u32 m0, s63, 0
    s_nop 0
    v_add_u32 v22, 61440, v15
    buffer_load_dwordx4 v22, s[64:67], 0 offen offset:0 sc1 lds
    buffer_load_dwordx4 v22, s[64:67], 0 offen offset:1024 sc1 lds
    buffer_load_dwordx4 v22, s[64:67], 0 offen offset:2048 sc1 lds
    buffer_load_dwordx4 v22, s[64:67], 0 offen offset:3072 sc1 lds
    s_add_u32 m0, s63, 4096
    v_add_u32 v22, 65536, v15
    buffer_load_dwordx4 v22, s[64:67], 0 offen offset:0 sc1 lds
    s_waitcnt vmcnt(20) lgkmcnt(0)
    s_barrier
    s_add_u32 m0, s63, 20480
    v_add_u32 v22, 81920, v15
    buffer_load_dwordx4 v22, s[64:67], 0 offen offset:0 sc1 lds
    buffer_load_dwordx4 v22, s[64:67], 0 offen offset:1024 sc1 lds
    buffer_load_dwordx4 v22, s[64:67], 0 offen offset:2048 sc1 lds
    buffer_load_dwordx4 v22, s[64:67], 0 offen offset:3072 sc1 lds
    s_add_u32 m0, s63, 24576
    v_add_u32 v22, 86016, v15
    buffer_load_dwordx4 v22, s[64:67], 0 offen offset:0 sc1 lds
    s_barrier
    s_waitcnt vmcnt(0)
    s_barrier
    s_cmp_lg_u32 s3, 0
    s_cbranch_scc1 kcd_pg
    s_mov_b64 exec, 1
    buffer_atomic_add v74, v21, s[76:79], 0 offen sc1
    s_mov_b32 s28, 0
kcd_pl:
    buffer_load_dword v20, v21, s[76:79], 0 offen sc1
    s_add_u32 s28, s28, 1
    s_waitcnt vmcnt(0)
    v_readfirstlane_b32 s29, v20
    s_nop 1
    s_cmp_ge_u32 s29, 8
    s_cbranch_scc1 kcd_po
    s_sleep 1
    s_cmp_lt_u32 s28, 1048576
    s_cbranch_scc1 kcd_pl
kcd_po:
    s_mov_b64 exec, -1
kcd_pg:
    s_barrier
    s_add_u32 m0, s26, 0
    s_mov_b32 s27, 0
    s_nop 0
    buffer_load_dwordx4 v4, s[68:71], s27 offen offset:0 sc1 lds
    buffer_load_dwordx4 v4, s[68:71], s27 offen offset:1024 sc1 lds
    buffer_load_dwordx4 v4, s[68:71], s27 offen offset:2048 sc1 lds
    buffer_load_dwordx4 v4, s[68:71], s27 offen offset:3072 sc1 lds
    s_add_u32 m0, s26, 4096
    s_mov_b32 s27, 4096
    buffer_load_dwordx4 v4, s[68:71], s27 offen offset:0 sc1 lds
    buffer_load_dwordx4 v4, s[68:71], s27 offen offset:1024 sc1 lds
    buffer_load_dwordx4 v4, s[68:71], s27 offen offset:2048 sc1 lds
    buffer_load_dwordx4 v4, s[68:71], s27 offen offset:3072 sc1 lds
    s_add_u32 m0, s26, 8192
    s_mov_b32 s27, 8192
    buffer_load_dwordx4 v4, s[68:71], s27 offen offset:0 sc1 lds
    buffer_load_dwordx4 v4, s[68:71], s27 offen offset:1024 sc1 lds
    buffer_load_dwordx4 v4, s[68:71], s27 offen offset:2048 sc1 lds
    buffer_load_dwordx4 v4, s[68:71], s27 offen offset:3072 sc1 lds
    s_waitcnt vmcnt(8)
    s_barrier
    s_add_u32 m0, s26, 12288
    s_mov_b32 s27, 12288
    buffer_load_dwordx4 v4, s[68:71], s27 offen offset:0 sc1 lds
    buffer_load_dwordx4 v4, s[68:71], s27 offen offset:1024 sc1 lds
    buffer_load_dwordx4 v4, s[68:71], s27 offen offset:2048 sc1 lds
    buffer_load_dwordx4 v4, s[68:71], s27 offen offset:3072 sc1 lds
    s_waitcnt vmcnt(8)
    s_barrier
    s_add_u32 m0, s26, 16384
    s_mov_b32 s27, 16384
    buffer_load_dwordx4 v4, s[68:71], s27 offen offset:0 sc1 lds
    buffer_load_dwordx4 v4, s[68:71], s27 offen offset:1024 sc1 lds
    buffer_load_dwordx4 v4, s[68:71], s27 offen offset:2048 sc1 lds
    buffer_load_dwordx4 v4, s[68:71], s27 offen offset:3072 sc1 lds
    s_add_u32 m0, s26, 20480
    s_mov_b32 s27, 20480
    buffer_load_dwordx4 v4, s[68:71], s27 offen offset:0 sc1 lds
    s_waitcnt vmcnt(8)
    s_barrier
    s_add_u32 m0, s26, 20480
    s_mov_b32 s27, 20480
    buffer_load_dwordx4 v4, s[68:71], s27 offen offset:1024 sc1 lds
    s_waitcnt vmcnt(4)
    s_barrier
    s_waitcnt vmcnt(0)
    s_barrier
    s_endpgm
kcd_comp:
    s_mul_i32 s16, s8, 192
    v_lshl_add_u32 v5, v3, 2, s16
    s_mul_i32 s16, s8, 196608
    v_add_u32 v6, s16, v4
    v_add_u32 v7, 0x10000, v6
    v_add_u32 v8, 0x20000, v6
    s_lshl_b32 s30, s4, 1
    s_add_u32 s30, s30, s7
    s_lshl_b32 s29, s30, 10
    v_lshlrev_b32 v21, 4, v9
    s_lshl_b32 s18, s30, 6
    s_lshl_b32 s19, s5, 8
    s_lshl_b32 s16, s8, 7
    s_add_u32 s19, s19, s16
    s_add_u32 s19, s19, 10240
    s_waitcnt lgkmcnt(0)
    s_mov_b32 s52, s86
    s_and_b32 s53, s87, 0xffff
    s_mov_b32 s54, 4096
    s_mov_b32 s55, 0x00020000
    buffer_load_dwordx4 v[228:231], v21, s[52:55], s18 offen
    s_lshl_b32 s16, s8, 7
    s_add_u32 s16, s16, 155648
    v_add_u32 v247, s16, v21
    s_lshl_b32 s16, s40, 16
    s_add_u32 s16, s16, 8388608
    s_lshl_b32 s17, s42, 16
    s_add_u32 s44, s36, s16
    s_addc_u32 s45, s37, 0
    s_and_b32 s45, s45, 0xffff
    s_mov_b32 s46, s17
    s_mov_b32 s47, 0x00020000
    s_lshl_b32 s16, s7, 1
    s_add_u32 s16, s16, 0
    v_xor_b32 v17, s16, v15
    v_lshl_add_u32 v10, v17, 5, v16
    s_lshl_b32 s16, s7, 1
    s_add_u32 s16, s16, 1
    v_xor_b32_e64 v17, s16, v15
    v_lshl_add_u32 v11, v17, 5, v16
    s_mul_i32 s16, s8, 3072
    s_add_u32 s16, s16, 69632
    v_add_u32 v12, s16, v4
    v_mov_b32 v18, v10
    v_mov_b32 v19, v11
    v_mov_b32 v20, v12
    v_mov_b32 v104, 0
    v_mov_b32 v105, 0
    v_mov_b32 v106, 0
    v_mov_b32 v107, 0
    v_mov_b32 v108, 0
    v_mov_b32 v109, 0
    v_mov_b32 v110, 0
    v_mov_b32 v111, 0
    v_mov_b32 v112, 0
    v_mov_b32 v113, 0
    v_mov_b32 v114, 0
    v_mov_b32 v115, 0
    v_mov_b32 v116, 0
    v_mov_b32 v117, 0
    v_mov_b32 v118, 0
    v_mov_b32 v119, 0
    v_mov_b32 v120, 0
    v_mov_b32 v121, 0
    v_mov_b32 v122, 0
    v_mov_b32 v123, 0
    v_mov_b32 v124, 0
    v_mov_b32 v125, 0
    v_mov_b32 v126, 0
    v_mov_b32 v127, 0
    v_mov_b32 v168, 0
    v_mov_b32 v169, 0
    v_mov_b32 v170, 0
    v_mov_b32 v171, 0
    v_mov_b32 v172, 0
    v_mov_b32 v173, 0
    v_mov_b32 v174, 0
    v_mov_b32 v175, 0
    v_mov_b32 v176, 0
    v_mov_b32 v177, 0
    v_mov_b32 v178, 0
    v_mov_b32 v179, 0
    v_mov_b32 v180, 0
    v_mov_b32 v181, 0
    v_mov_b32 v182, 0
    v_mov_b32 v183, 0
    v_mov_b32 v0, 0xc0135761
    s_mov_b32 s60, 0xbdd2d3e8
    s_lshl_b32 s16, s7, 7
    v_lshl_add_u32 v13, v9, 4, s16
    s_mul_i32 s24, s30, 88
    s_mul_i32 s25, s8, 3
    s_add_u32 s25, s25, s41
    s_add_u32 s24, s24, s25
    s_lshl_b32 s24, s24, 9
    s_add_u32 s24, s24, 14680064
    s_lshr_b32 s26, 0x95, s5
    s_and_b32 s26, s26, 1
    s_add_u32 s26, s26, 2
    s_cmp_eq_u32 s8, 0
    s_cselect_b32 s26, 3, s26
    s_lshl_b32 s26, s26, 9
    s_add_u32 s48, s36, s24
    s_addc_u32 s49, s37, 0
    s_and_b32 s49, s49, 0xffff
    s_mov_b32 s50, s26
    s_mov_b32 s51, 0x00020000
    s_add_u32 s24, s24, 22528
    s_add_u32 s56, s36, s24
    s_addc_u32 s57, s37, 0
    s_and_b32 s57, s57, 0xffff
    s_mov_b32 s58, s26
    s_mov_b32 s59, 0x00020000
    s_mov_b32 s80, s38
    s_and_b32 s81, s39, 0xffff
    s_mov_b32 s82, 2097152
    s_mov_b32 s83, 0x00020000
    v_lshrrev_b32 v22, 2, v3
    v_lshlrev_b32 v22, 3, v22
    v_and_b32 v17, 3, v3
    v_add_u32 v22, v22, v17
    v_lshlrev_b32 v22, 10, v22
    v_lshl_add_u32 v22, v9, 3, v22
    s_lshl_b32 s64, s30, 15
    s_lshl_b32 s65, s5, 7
    s_add_u32 s64, s64, s65
    s_lshl_b32 s65, s8, 6
    s_add_u32 s64, s64, s65
    s_add_u32 s65, s64, 4096
    v_lshrrev_b32 v21, 1, v9
    v_lshlrev_b32 v21, 2, v21
    v_xor_b32 v21, v21, v1
    v_lshlrev_b32_e64 v21, 3, v21
    v_bfe_u32 v14, v1, 2, 2
    v_lshl_add_u32 v17, v9, 2, v14
    v_lshlrev_b32 v17, 7, v17
    v_and_b32 v2, 3, v1
    v_lshl_add_u32 v17, v2, 3, v17
    s_sub_u32 s16, s5, s9
    s_and_b32 s16, s16, 7
    s_lshl_b32 s16, s16, 13
    s_lshl_b32 s17, s8, 12
    s_add_u32 s16, s16, s17
    s_add_u32 s16, s16, 4096
    v_add_u32 v17, s16, v17
    v_lshrrev_b32 v14, 1, v14
    v_and_b32 v2, 2, v9
    v_or_b32 v14, v14, v2
    s_lshl_b32 s16, s7, 1
    v_xor_b32_e64 v14, s16, v14
    v_lshl_add_u32 v2, v14, 5, v17
    v_xor_b32 v14, 32, v2
    s_waitcnt vmcnt(1)
    s_barrier
    v_mov_b32 v17, v247
    ds_read_b128 v[240:243], v17 offset:0
    ds_read_b128 v[244:247], v17 offset:64
    s_barrier
    s_waitcnt lgkmcnt(0)
    s_barrier
    s_nop 0
    ds_read_b64_tr_b16 v[24:25], v18 offset:0
    ds_read_b64_tr_b16 v[26:27], v18 offset:512
    ds_read_b64_tr_b16 v[28:29], v19 offset:0
    ds_read_b64_tr_b16 v[30:31], v19 offset:512
    ds_read_b128 v[32:35], v20 offset:0
    ds_read_b128 v[36:39], v20 offset:1024
    ds_read_b128 v[40:43], v20 offset:2048
    ds_read_b64_tr_b16 v[44:45], v18 offset:4096
    ds_read_b64_tr_b16 v[46:47], v18 offset:4608
    ds_read_b64_tr_b16 v[48:49], v19 offset:4096
    ds_read_b64_tr_b16 v[50:51], v19 offset:4608
    ds_read_b128 v[52:55], v20 offset:6144
    ds_read_b128 v[56:59], v20 offset:7168
    ds_read_b128 v[60:63], v20 offset:8192
    s_mov_b32 s28, 0
    s_mov_b32 s70, 8192
    s_mov_b32 s71, 12288
    v_add_u32 v18, s70, v10
    v_add_u32 v19, s70, v11
    v_add_u32 v20, s71, v12
    .p2align 6
kcd_cloop:
    s_waitcnt lgkmcnt(7)
    s_barrier
    v_mfma_f32_16x16x32_bf16 v[104:107], v[24:27], v[32:35], v[104:107]
    ds_read_b64_tr_b16 v[64:65], v18 offset:0
    ds_read_b64_tr_b16 v[66:67], v18 offset:512
    v_mfma_f32_16x16x32_bf16 v[116:119], v[28:31], v[32:35], v[116:119]
    ds_read_b64_tr_b16 v[68:69], v19 offset:0
    ds_read_b64_tr_b16 v[70:71], v19 offset:512
    v_mfma_f32_16x16x32_bf16 v[108:111], v[24:27], v[36:39], v[108:111]
    ds_read_b128 v[72:75], v20 offset:0
    s_add_u32 s70, s70, 8192
    v_mfma_f32_16x16x32_bf16 v[120:123], v[28:31], v[36:39], v[120:123]
    ds_read_b128 v[76:79], v20 offset:1024
    s_and_b32 s70, s70, 0xffff
    v_mfma_f32_16x16x32_bf16 v[112:115], v[24:27], v[40:43], v[112:115]
    ds_read_b128 v[80:83], v20 offset:2048
    s_add_u32 s71, s71, 12288
    v_mfma_f32_16x16x32_bf16 v[124:127], v[28:31], v[40:43], v[124:127]
    s_cmp_eq_u32 s71, 86016
    s_cselect_b32 s71, 0, s71
    s_waitcnt lgkmcnt(7)
    v_mfma_f32_16x16x32_bf16 v[104:107], v[44:47], v[52:55], v[104:107]
    ds_read_b64_tr_b16 v[84:85], v18 offset:4096
    ds_read_b64_tr_b16 v[86:87], v18 offset:4608
    v_mfma_f32_16x16x32_bf16 v[116:119], v[48:51], v[52:55], v[116:119]
    ds_read_b64_tr_b16 v[88:89], v19 offset:4096
    ds_read_b64_tr_b16 v[90:91], v19 offset:4608
    v_mfma_f32_16x16x32_bf16 v[108:111], v[44:47], v[56:59], v[108:111]
    ds_read_b128 v[92:95], v20 offset:6144
    v_add_u32_e64 v18, s70, v10
    v_mfma_f32_16x16x32_bf16 v[120:123], v[48:51], v[56:59], v[120:123]
    ds_read_b128 v[96:99], v20 offset:7168
    v_add_u32_e64 v19, s70, v11
    v_mfma_f32_16x16x32_bf16 v[112:115], v[44:47], v[60:63], v[112:115]
    ds_read_b128 v[100:103], v20 offset:8192
    v_mfma_f32_16x16x32_bf16 v[124:127], v[48:51], v[60:63], v[124:127]
    v_add_u32 v20, s71, v12
    s_waitcnt lgkmcnt(7)
    s_barrier
    s_nop 0
    v_mfma_f32_16x16x32_bf16 v[104:107], v[64:67], v[72:75], v[104:107]
    ds_read_b64_tr_b16 v[24:25], v18 offset:0
    ds_read_b64_tr_b16 v[26:27], v18 offset:512
    v_mfma_f32_16x16x32_bf16 v[116:119], v[68:71], v[72:75], v[116:119]
    ds_read_b64_tr_b16 v[28:29], v19 offset:0
    ds_read_b64_tr_b16 v[30:31], v19 offset:512
    v_mfma_f32_16x16x32_bf16 v[108:111], v[64:67], v[76:79], v[108:111]
    ds_read_b128 v[32:35], v20 offset:0
    s_add_u32 s70, s70, 8192
    v_mfma_f32_16x16x32_bf16 v[120:123], v[68:71], v[76:79], v[120:123]
    ds_read_b128 v[36:39], v20 offset:1024
    s_and_b32 s70, s70, 0xffff
    v_mfma_f32_16x16x32_bf16 v[112:115], v[64:67], v[80:83], v[112:115]
    ds_read_b128 v[40:43], v20 offset:2048
    s_add_u32 s71, s71, 12288
    v_mfma_f32_16x16x32_bf16 v[124:127], v[68:71], v[80:83], v[124:127]
    s_cmp_eq_u32 s71, 86016
    s_cselect_b32 s71, 0, s71
    s_waitcnt lgkmcnt(7)
    v_mfma_f32_16x16x32_bf16 v[104:107], v[84:87], v[92:95], v[104:107]
    ds_read_b64_tr_b16 v[44:45], v18 offset:4096
    ds_read_b64_tr_b16 v[46:47], v18 offset:4608
    v_mfma_f32_16x16x32_bf16 v[116:119], v[88:91], v[92:95], v[116:119]
    ds_read_b64_tr_b16 v[48:49], v19 offset:4096
    ds_read_b64_tr_b16 v[50:51], v19 offset:4608
    v_mfma_f32_16x16x32_bf16 v[108:111], v[84:87], v[96:99], v[108:111]
    ds_read_b128 v[52:55], v20 offset:6144
    v_add_u32_e64 v18, s70, v10
    v_mfma_f32_16x16x32_bf16 v[120:123], v[88:91], v[96:99], v[120:123]
    ds_read_b128 v[56:59], v20 offset:7168
    v_add_u32_e64 v19, s70, v11
    v_mfma_f32_16x16x32_bf16 v[112:115], v[84:87], v[100:103], v[112:115]
    ds_read_b128 v[60:63], v20 offset:8192
    v_mfma_f32_16x16x32_bf16 v[124:127], v[88:91], v[100:103], v[124:127]
    v_add_u32 v20, s71, v12
    s_add_u32 s28, s28, 2
    s_cmp_eq_u32 s28, 16
    s_cbranch_scc1 kcd_last
    s_cmp_lg_u32 s28, 8
    s_cbranch_scc1 kcd_cloop
    s_barrier
    s_nop 0
    ds_read_b128 v[128:131], v13 offset:0
    ds_read_b128 v[132:135], v13 offset:256
    ds_read_b128 v[136:139], v13 offset:64
    ds_read_b128 v[140:143], v13 offset:320
    ds_read_b32 v204, v5 offset:2048
    ds_read_b32 v206, v5 offset:2432
    ds_read_b32 v208, v5 offset:2112
    ds_read_b32 v210, v5 offset:2496
    ds_read_b32 v212, v5 offset:2176
    ds_read_b32 v214, v5 offset:2560
    s_waitcnt lgkmcnt(0)
    s_nop 0
    ds_read_b32 v216, v5 offset:2816
    ds_read_b32 v218, v5 offset:3200
    ds_read_b32 v220, v5 offset:2880
    ds_read_b32 v222, v5 offset:3264
    ds_read_b32 v224, v5 offset:2944
    ds_read_b32 v226, v5 offset:3328
    ds_read_b64_tr_b16 v[232:233], v2 offset:0
    ds_read_b64_tr_b16 v[234:235], v2 offset:2048
    ds_read_b64_tr_b16 v[236:237], v14 offset:0
    ds_read_b64_tr_b16 v[238:239], v14 offset:2048
    v_pk_fma_f32 v[144:145], v[132:133], v[204:205], v[206:207] op_sel_hi:[1,0,0] neg_lo:[1,0,0] neg_hi:[1,0,0]
    v_pk_fma_f32 v[146:147], v[134:135], v[204:205], v[206:207] op_sel_hi:[1,0,0] neg_lo:[1,0,0] neg_hi:[1,0,0]
    v_pk_fma_f32 v[148:149], v[140:141], v[204:205], v[206:207] op_sel_hi:[1,0,0] neg_lo:[1,0,0] neg_hi:[1,0,0]
    v_pk_fma_f32 v[150:151], v[142:143], v[204:205], v[206:207] op_sel_hi:[1,0,0] neg_lo:[1,0,0] neg_hi:[1,0,0]
    v_pk_fma_f32 v[152:153], v[132:133], v[208:209], v[210:211] op_sel_hi:[1,0,0] neg_lo:[1,0,0] neg_hi:[1,0,0]
    v_pk_fma_f32 v[154:155], v[134:135], v[208:209], v[210:211] op_sel_hi:[1,0,0] neg_lo:[1,0,0] neg_hi:[1,0,0]
    v_pk_fma_f32 v[156:157], v[140:141], v[208:209], v[210:211] op_sel_hi:[1,0,0] neg_lo:[1,0,0] neg_hi:[1,0,0]
    v_pk_fma_f32 v[158:159], v[142:143], v[208:209], v[210:211] op_sel_hi:[1,0,0] neg_lo:[1,0,0] neg_hi:[1,0,0]
    v_pk_fma_f32 v[160:161], v[132:133], v[212:213], v[214:215] op_sel_hi:[1,0,0] neg_lo:[1,0,0] neg_hi:[1,0,0]
    v_pk_fma_f32 v[162:163], v[134:135], v[212:213], v[214:215] op_sel_hi:[1,0,0] neg_lo:[1,0,0] neg_hi:[1,0,0]
    v_pk_fma_f32 v[164:165], v[140:141], v[212:213], v[214:215] op_sel_hi:[1,0,0] neg_lo:[1,0,0] neg_hi:[1,0,0]
    v_pk_fma_f32 v[166:167], v[142:143], v[212:213], v[214:215] op_sel_hi:[1,0,0] neg_lo:[1,0,0] neg_hi:[1,0,0]
    v_pk_fma_f32 v[144:145], v[104:105], v[128:129], v[144:145]
    v_pk_fma_f32 v[146:147], v[106:107], v[130:131], v[146:147]
    v_pk_fma_f32 v[148:149], v[116:117], v[136:137], v[148:149]
    v_pk_fma_f32 v[150:151], v[118:119], v[138:139], v[150:151]
    v_pk_fma_f32 v[152:153], v[108:109], v[128:129], v[152:153]
    v_pk_fma_f32 v[154:155], v[110:111], v[130:131], v[154:155]
    v_pk_fma_f32 v[156:157], v[120:121], v[136:137], v[156:157]
    v_pk_fma_f32 v[158:159], v[122:123], v[138:139], v[158:159]
    v_pk_fma_f32 v[160:161], v[112:113], v[128:129], v[160:161]
    v_pk_fma_f32 v[162:163], v[114:115], v[130:131], v[162:163]
    v_pk_fma_f32 v[164:165], v[124:125], v[136:137], v[164:165]
    v_pk_fma_f32 v[166:167], v[126:127], v[138:139], v[166:167]
    v_cvt_pk_bf16_f32 v104, v144, v145
    v_cvt_pk_bf16_f32 v106, v146, v147
    v_cvt_pk_bf16_f32 v108, v148, v149
    v_cvt_pk_bf16_f32 v110, v150, v151
    v_cvt_pk_bf16_f32 v112, v152, v153
    v_cvt_pk_bf16_f32 v114, v154, v155
    v_cvt_pk_bf16_f32 v116, v156, v157
    v_cvt_pk_bf16_f32 v118, v158, v159
    v_cvt_pk_bf16_f32 v120, v160, v161
    v_cvt_pk_bf16_f32 v122, v162, v163
    v_cvt_pk_bf16_f32 v124, v164, v165
    v_cvt_pk_bf16_f32 v126, v166, v167
    v_lshlrev_b32 v144, 16, v104
    v_and_b32 v145, s97, v104
    v_lshlrev_b32 v146, 16, v106
    v_and_b32 v147, s97, v106
    v_lshlrev_b32 v148, 16, v108
    v_and_b32 v149, s97, v108
    v_lshlrev_b32 v150, 16, v110
    v_and_b32 v151, s97, v110
    v_lshlrev_b32 v152, 16, v112
    v_and_b32 v153, s97, v112
    v_lshlrev_b32 v154, 16, v114
    v_and_b32 v155, s97, v114
    v_lshlrev_b32 v156, 16, v116
    v_and_b32 v157, s97, v116
    v_lshlrev_b32 v158, 16, v118
    v_and_b32 v159, s97, v118
    v_lshlrev_b32 v160, 16, v120
    v_and_b32 v161, s97, v120
    v_lshlrev_b32 v162, 16, v122
    v_and_b32 v163, s97, v122
    v_lshlrev_b32 v164, 16, v124
    v_and_b32 v165, s97, v124
    v_lshlrev_b32 v166, 16, v126
    v_and_b32 v167, s97, v126
    v_pk_mul_f32 v[104:105], v[144:145], v[144:145]
    v_pk_mul_f32 v[106:107], v[146:147], v[146:147]
    v_pk_mul_f32 v[108:109], v[148:149], v[148:149]
    v_pk_mul_f32 v[110:111], v[150:151], v[150:151]
    v_pk_mul_f32 v[112:113], v[152:153], v[152:153]
    v_pk_mul_f32 v[114:115], v[154:155], v[154:155]
    v_pk_mul_f32 v[116:117], v[156:157], v[156:157]
    v_pk_mul_f32 v[118:119], v[158:159], v[158:159]
    v_pk_mul_f32 v[120:121], v[160:161], v[160:161]
    v_pk_mul_f32 v[122:123], v[162:163], v[162:163]
    v_pk_mul_f32 v[124:125], v[164:165], v[164:165]
    v_pk_mul_f32 v[126:127], v[166:167], v[166:167]
    v_pk_fma_f32 v[104:105], v[104:105], s[60:61], v[0:1] op_sel_hi:[1,0,0]
    v_pk_fma_f32 v[106:107], v[106:107], s[60:61], v[0:1] op_sel_hi:[1,0,0]
    v_pk_fma_f32 v[108:109], v[108:109], s[60:61], v[0:1] op_sel_hi:[1,0,0]
    v_pk_fma_f32 v[110:111], v[110:111], s[60:61], v[0:1] op_sel_hi:[1,0,0]
    v_pk_fma_f32 v[112:113], v[112:113], s[60:61], v[0:1] op_sel_hi:[1,0,0]
    v_pk_fma_f32 v[114:115], v[114:115], s[60:61], v[0:1] op_sel_hi:[1,0,0]
    v_pk_fma_f32 v[116:117], v[116:117], s[60:61], v[0:1] op_sel_hi:[1,0,0]
    v_pk_fma_f32 v[118:119], v[118:119], s[60:61], v[0:1] op_sel_hi:[1,0,0]
    v_pk_fma_f32 v[120:121], v[120:121], s[60:61], v[0:1] op_sel_hi:[1,0,0]
    v_pk_fma_f32 v[122:123], v[122:123], s[60:61], v[0:1] op_sel_hi:[1,0,0]
    v_pk_fma_f32 v[124:125], v[124:125], s[60:61], v[0:1] op_sel_hi:[1,0,0]
    v_pk_fma_f32 v[126:127], v[126:127], s[60:61], v[0:1] op_sel_hi:[1,0,0]
    v_pk_mul_f32 v[104:105], v[104:105], v[144:145]
    v_pk_mul_f32 v[106:107], v[106:107], v[146:147]
    v_pk_mul_f32 v[108:109], v[108:109], v[148:149]
    v_pk_mul_f32 v[110:111], v[110:111], v[150:151]
    v_pk_mul_f32 v[112:113], v[112:113], v[152:153]
    v_pk_mul_f32 v[114:115], v[114:115], v[154:155]
    v_pk_mul_f32 v[116:117], v[116:117], v[156:157]
    v_pk_mul_f32 v[118:119], v[118:119], v[158:159]
    v_pk_mul_f32 v[120:121], v[120:121], v[160:161]
    v_pk_mul_f32 v[122:123], v[122:123], v[162:163]
    v_pk_mul_f32 v[124:125], v[124:125], v[164:165]
    v_pk_mul_f32 v[126:127], v[126:127], v[166:167]
    v_exp_f32 v104, v104
    v_exp_f32 v105, v105
    v_exp_f32 v106, v106
    v_exp_f32 v107, v107
    v_exp_f32 v108, v108
    v_exp_f32 v109, v109
    v_exp_f32 v110, v110
    v_exp_f32 v111, v111
    v_exp_f32 v112, v112
    v_exp_f32 v113, v113
    v_exp_f32 v114, v114
    v_exp_f32 v115, v115
    v_exp_f32 v116, v116
    v_exp_f32 v117, v117
    v_exp_f32 v118, v118
    v_exp_f32 v119, v119
    v_exp_f32 v120, v120
    v_exp_f32 v121, v121
    v_exp_f32 v122, v122
    v_exp_f32 v123, v123
    v_exp_f32 v124, v124
    v_exp_f32 v125, v125
    v_exp_f32 v126, v126
    v_exp_f32 v127, v127
    v_pk_add_f32 v[104:105], v[104:105], 1.0 op_sel_hi:[1,0]
    v_pk_add_f32 v[106:107], v[106:107], 1.0 op_sel_hi:[1,0]
    v_pk_add_f32 v[108:109], v[108:109], 1.0 op_sel_hi:[1,0]
    v_pk_add_f32 v[110:111], v[110:111], 1.0 op_sel_hi:[1,0]
    v_pk_add_f32 v[112:113], v[112:113], 1.0 op_sel_hi:[1,0]
    v_pk_add_f32 v[114:115], v[114:115], 1.0 op_sel_hi:[1,0]
    v_pk_add_f32 v[116:117], v[116:117], 1.0 op_sel_hi:[1,0]
    v_pk_add_f32 v[118:119], v[118:119], 1.0 op_sel_hi:[1,0]
    v_pk_add_f32 v[120:121], v[120:121], 1.0 op_sel_hi:[1,0]
    v_pk_add_f32 v[122:123], v[122:123], 1.0 op_sel_hi:[1,0]
    v_pk_add_f32 v[124:125], v[124:125], 1.0 op_sel_hi:[1,0]
    v_pk_add_f32 v[126:127], v[126:127], 1.0 op_sel_hi:[1,0]
    v_rcp_f32 v104, v104
    v_rcp_f32 v105, v105
    v_rcp_f32 v106, v106
    v_rcp_f32 v107, v107
    v_rcp_f32 v108, v108
    v_rcp_f32 v109, v109
    v_rcp_f32 v110, v110
    v_rcp_f32 v111, v111
    v_rcp_f32 v112, v112
    v_rcp_f32 v113, v113
    v_rcp_f32 v114, v114
    v_rcp_f32 v115, v115
    v_rcp_f32 v116, v116
    v_rcp_f32 v117, v117
    v_rcp_f32 v118, v118
    v_rcp_f32 v119, v119
    v_rcp_f32 v120, v120
    v_rcp_f32 v121, v121
    v_rcp_f32 v122, v122
    v_rcp_f32 v123, v123
    v_rcp_f32 v124, v124
    v_rcp_f32 v125, v125
    v_rcp_f32 v126, v126
    v_rcp_f32 v127, v127
    v_pk_mul_f32 v[144:145], v[144:145], v[104:105]
    v_pk_mul_f32 v[146:147], v[146:147], v[106:107]
    v_pk_mul_f32 v[148:149], v[148:149], v[108:109]
    v_pk_mul_f32 v[150:151], v[150:151], v[110:111]
    v_pk_mul_f32 v[152:153], v[152:153], v[112:113]
    v_pk_mul_f32 v[154:155], v[154:155], v[114:115]
    v_pk_mul_f32 v[156:157], v[156:157], v[116:117]
    v_pk_mul_f32 v[158:159], v[158:159], v[118:119]
    v_pk_mul_f32 v[160:161], v[160:161], v[120:121]
    v_pk_mul_f32 v[162:163], v[162:163], v[122:123]
    v_pk_mul_f32 v[164:165], v[164:165], v[124:125]
    v_pk_mul_f32 v[166:167], v[166:167], v[126:127]
    v_cvt_pk_bf16_f32 v192, v144, v145
    v_cvt_pk_bf16_f32 v193, v146, v147
    v_cvt_pk_bf16_f32 v194, v148, v149
    v_cvt_pk_bf16_f32 v195, v150, v151
    v_cvt_pk_bf16_f32 v196, v152, v153
    v_cvt_pk_bf16_f32 v197, v154, v155
    v_cvt_pk_bf16_f32 v198, v156, v157
    v_cvt_pk_bf16_f32 v199, v158, v159
    v_cvt_pk_bf16_f32 v200, v160, v161
    v_cvt_pk_bf16_f32 v201, v162, v163
    v_cvt_pk_bf16_f32 v202, v164, v165
    v_cvt_pk_bf16_f32 v203, v166, v167
    v_lshlrev_b32 v144, 16, v192
    v_and_b32 v145, s97, v192
    v_lshlrev_b32 v146, 16, v193
    v_and_b32 v147, s97, v193
    v_lshlrev_b32 v148, 16, v194
    v_and_b32 v149, s97, v194
    v_lshlrev_b32 v150, 16, v195
    v_and_b32 v151, s97, v195
    v_lshlrev_b32 v152, 16, v196
    v_and_b32 v153, s97, v196
    v_lshlrev_b32 v154, 16, v197
    v_and_b32 v155, s97, v197
    v_lshlrev_b32 v156, 16, v198
    v_and_b32 v157, s97, v198
    v_lshlrev_b32 v158, 16, v199
    v_and_b32 v159, s97, v199
    v_lshlrev_b32 v160, 16, v200
    v_and_b32 v161, s97, v200
    v_lshlrev_b32 v162, 16, v201
    v_and_b32 v163, s97, v201
    v_lshlrev_b32 v164, 16, v202
    v_and_b32 v165, s97, v202
    v_lshlrev_b32 v166, 16, v203
    v_and_b32 v167, s97, v203
    v_pk_add_f32 v[168:169], v[144:145], v[152:153]
    v_pk_mul_f32 v[176:177], v[144:145], v[144:145]
    v_pk_add_f32 v[170:171], v[146:147], v[154:155]
    v_pk_mul_f32 v[178:179], v[146:147], v[146:147]
    v_pk_add_f32 v[172:173], v[148:149], v[156:157]
    v_pk_mul_f32 v[180:181], v[148:149], v[148:149]
    v_pk_add_f32 v[174:175], v[150:151], v[158:159]
    v_pk_mul_f32 v[182:183], v[150:151], v[150:151]
    v_pk_add_f32 v[168:169], v[168:169], v[160:161]
    v_pk_fma_f32 v[176:177], v[152:153], v[152:153], v[176:177]
    v_pk_add_f32 v[170:171], v[170:171], v[162:163]
    v_pk_fma_f32 v[178:179], v[154:155], v[154:155], v[178:179]
    v_pk_add_f32 v[172:173], v[172:173], v[164:165]
    v_pk_fma_f32 v[180:181], v[156:157], v[156:157], v[180:181]
    v_pk_add_f32 v[174:175], v[174:175], v[166:167]
    v_pk_fma_f32 v[182:183], v[158:159], v[158:159], v[182:183]
    v_pk_fma_f32 v[176:177], v[160:161], v[160:161], v[176:177]
    v_pk_fma_f32 v[178:179], v[162:163], v[162:163], v[178:179]
    v_pk_fma_f32 v[180:181], v[164:165], v[164:165], v[180:181]
    v_pk_fma_f32 v[182:183], v[166:167], v[166:167], v[182:183]
    v_add_f32_dpp v184, v168, v168 row_ror:8 row_mask:0xf bank_mask:0x3
    s_nop 1
    v_add_f32_dpp v184, v172, v172 row_ror:8 row_mask:0xf bank_mask:0xc
    v_add_f32_dpp v185, v176, v176 row_ror:8 row_mask:0xf bank_mask:0x3
    s_nop 1
    v_add_f32_dpp v185, v180, v180 row_ror:8 row_mask:0xf bank_mask:0xc
    v_add_f32_dpp v186, v169, v169 row_ror:8 row_mask:0xf bank_mask:0x3
    s_nop 1
    v_add_f32_dpp v186, v173, v173 row_ror:8 row_mask:0xf bank_mask:0xc
    v_add_f32_dpp v187, v177, v177 row_ror:8 row_mask:0xf bank_mask:0x3
    s_nop 1
    v_add_f32_dpp v187, v181, v181 row_ror:8 row_mask:0xf bank_mask:0xc
    v_add_f32_dpp v188, v170, v170 row_ror:8 row_mask:0xf bank_mask:0x3
    s_nop 1
    v_add_f32_dpp v188, v174, v174 row_ror:8 row_mask:0xf bank_mask:0xc
    v_add_f32_dpp v189, v178, v178 row_ror:8 row_mask:0xf bank_mask:0x3
    s_nop 1
    v_add_f32_dpp v189, v182, v182 row_ror:8 row_mask:0xf bank_mask:0xc
    v_add_f32_dpp v190, v171, v171 row_ror:8 row_mask:0xf bank_mask:0x3
    s_nop 1
    v_add_f32_dpp v190, v175, v175 row_ror:8 row_mask:0xf bank_mask:0xc
    v_add_f32_dpp v191, v179, v179 row_ror:8 row_mask:0xf bank_mask:0x3
    s_nop 1
    v_add_f32_dpp v191, v183, v183 row_ror:8 row_mask:0xf bank_mask:0xc
    v_add_f32_dpp v168, v184, v184 row_half_mirror row_mask:0xf bank_mask:0x5
    s_nop 1
    v_add_f32_dpp v168, v188, v188 row_half_mirror row_mask:0xf bank_mask:0xa
    v_add_f32_dpp v169, v185, v185 row_half_mirror row_mask:0xf bank_mask:0x5
    s_nop 1
    v_add_f32_dpp v169, v189, v189 row_half_mirror row_mask:0xf bank_mask:0xa
    v_add_f32_dpp v170, v186, v186 row_half_mirror row_mask:0xf bank_mask:0x5
    s_nop 1
    v_add_f32_dpp v170, v190, v190 row_half_mirror row_mask:0xf bank_mask:0xa
    v_add_f32_dpp v171, v187, v187 row_half_mirror row_mask:0xf bank_mask:0x5
    s_nop 1
    v_add_f32_dpp v171, v191, v191 row_half_mirror row_mask:0xf bank_mask:0xa
    v_add_f32_dpp v168, v168, v168 quad_perm:[2,3,0,1] row_mask:0xf bank_mask:0xf
    v_add_f32_dpp v169, v169, v169 quad_perm:[2,3,0,1] row_mask:0xf bank_mask:0xf
    v_add_f32_dpp v170, v170, v170 quad_perm:[2,3,0,1] row_mask:0xf bank_mask:0xf
    v_add_f32_dpp v171, v171, v171 quad_perm:[2,3,0,1] row_mask:0xf bank_mask:0xf
    v_add_f32_dpp v168, v168, v168 quad_perm:[1,0,3,2] row_mask:0xf bank_mask:0xf
    v_add_f32_dpp v169, v169, v169 quad_perm:[1,0,3,2] row_mask:0xf bank_mask:0xf
    v_add_f32_dpp v170, v170, v170 quad_perm:[1,0,3,2] row_mask:0xf bank_mask:0xf
    v_add_f32_dpp v171, v171, v171 quad_perm:[1,0,3,2] row_mask:0xf bank_mask:0xf
    v_bfe_u32 v17, v1, 3, 1
    v_lshlrev_b32_e64 v17, 7, v17
    v_lshl_add_u32 v17, v9, 5, v17
    v_bfe_u32 v14, v1, 2, 1
    v_lshl_add_u32 v17, v14, 4, v17
    s_lshl_b32 s16, s7, 8
    s_lshl_b32 s17, s8, 9
    s_add_u32 s16, s16, s17
    v_add_u32 v17, s16, v17
    ds_write_b128 v17, v[168:171] offset:512
    v_mov_b64 v[104:105], 0
    v_mov_b64 v[106:107], 0
    v_mov_b64 v[108:109], 0
    v_mov_b64 v[110:111], 0
    v_mov_b64 v[112:113], 0
    v_mov_b64 v[114:115], 0
    v_mov_b64 v[116:117], 0
    v_mov_b64 v[118:119], 0
    v_mov_b64 v[120:121], 0
    v_mov_b64 v[122:123], 0
    v_mov_b64 v[124:125], 0
    v_mov_b64 v[126:127], 0
    s_waitcnt lgkmcnt(0)
    s_barrier
    s_branch kcd_cloop
kcd_last:
    s_waitcnt lgkmcnt(0)
    v_pk_fma_f32 v[64:65], v[132:133], v[216:217], v[218:219] op_sel_hi:[1,0,0] neg_lo:[1,0,0] neg_hi:[1,0,0]
    v_pk_fma_f32 v[66:67], v[134:135], v[216:217], v[218:219] op_sel_hi:[1,0,0] neg_lo:[1,0,0] neg_hi:[1,0,0]
    v_pk_fma_f32 v[68:69], v[140:141], v[216:217], v[218:219] op_sel_hi:[1,0,0] neg_lo:[1,0,0] neg_hi:[1,0,0]
    v_pk_fma_f32 v[70:71], v[142:143], v[216:217], v[218:219] op_sel_hi:[1,0,0] neg_lo:[1,0,0] neg_hi:[1,0,0]
    v_pk_fma_f32 v[72:73], v[132:133], v[220:221], v[222:223] op_sel_hi:[1,0,0] neg_lo:[1,0,0] neg_hi:[1,0,0]
    v_pk_fma_f32 v[74:75], v[134:135], v[220:221], v[222:223] op_sel_hi:[1,0,0] neg_lo:[1,0,0] neg_hi:[1,0,0]
    v_pk_fma_f32 v[76:77], v[140:141], v[220:221], v[222:223] op_sel_hi:[1,0,0] neg_lo:[1,0,0] neg_hi:[1,0,0]
    v_pk_fma_f32 v[78:79], v[142:143], v[220:221], v[222:223] op_sel_hi:[1,0,0] neg_lo:[1,0,0] neg_hi:[1,0,0]
    v_pk_fma_f32 v[80:81], v[132:133], v[224:225], v[226:227] op_sel_hi:[1,0,0] neg_lo:[1,0,0] neg_hi:[1,0,0]
    v_pk_fma_f32 v[82:83], v[134:135], v[224:225], v[226:227] op_sel_hi:[1,0,0] neg_lo:[1,0,0] neg_hi:[1,0,0]
    v_pk_fma_f32 v[84:85], v[140:141], v[224:225], v[226:227] op_sel_hi:[1,0,0] neg_lo:[1,0,0] neg_hi:[1,0,0]
    v_pk_fma_f32 v[86:87], v[142:143], v[224:225], v[226:227] op_sel_hi:[1,0,0] neg_lo:[1,0,0] neg_hi:[1,0,0]
    v_pk_fma_f32 v[64:65], v[104:105], v[128:129], v[64:65]
    v_pk_fma_f32 v[66:67], v[106:107], v[130:131], v[66:67]
    v_pk_fma_f32 v[68:69], v[116:117], v[136:137], v[68:69]
    v_pk_fma_f32 v[70:71], v[118:119], v[138:139], v[70:71]
    v_pk_fma_f32 v[72:73], v[108:109], v[128:129], v[72:73]
    v_pk_fma_f32 v[74:75], v[110:111], v[130:131], v[74:75]
    v_pk_fma_f32 v[76:77], v[120:121], v[136:137], v[76:77]
    v_pk_fma_f32 v[78:79], v[122:123], v[138:139], v[78:79]
    v_pk_fma_f32 v[80:81], v[112:113], v[128:129], v[80:81]
    v_pk_fma_f32 v[82:83], v[114:115], v[130:131], v[82:83]
    v_pk_fma_f32 v[84:85], v[124:125], v[136:137], v[84:85]
    v_pk_fma_f32 v[86:87], v[126:127], v[138:139], v[86:87]
    v_cvt_pk_bf16_f32 v192, v64, v65
    v_cvt_pk_bf16_f32 v193, v66, v67
    v_cvt_pk_bf16_f32 v194, v68, v69
    v_cvt_pk_bf16_f32 v195, v70, v71
    v_cvt_pk_bf16_f32 v196, v72, v73
    v_cvt_pk_bf16_f32 v197, v74, v75
    v_cvt_pk_bf16_f32 v198, v76, v77
    v_cvt_pk_bf16_f32 v199, v78, v79
    v_cvt_pk_bf16_f32 v200, v80, v81
    v_cvt_pk_bf16_f32 v201, v82, v83
    v_cvt_pk_bf16_f32 v202, v84, v85
    v_cvt_pk_bf16_f32 v203, v86, v87
    s_barrier
    ds_read_b128 v[128:131], v13 offset:1536
    ds_read_b128 v[132:135], v13 offset:1792
    ds_read_b128 v[136:139], v13 offset:1600
    ds_read_b128 v[140:143], v13 offset:1856
    s_waitcnt lgkmcnt(0)
    v_pk_fma_f32 v[144:145], v[144:145], v[128:129], v[132:133]
    v_pk_fma_f32 v[146:147], v[146:147], v[130:131], v[134:135]
    v_pk_fma_f32 v[148:149], v[148:149], v[136:137], v[140:141]
    v_pk_fma_f32 v[150:151], v[150:151], v[138:139], v[142:143]
    v_cvt_pk_bf16_f32 v24, v144, v145
    v_cvt_pk_bf16_f32 v25, v146, v147
    v_cvt_pk_bf16_f32 v26, v148, v149
    v_cvt_pk_bf16_f32 v27, v150, v151
    buffer_store_dwordx4 v[24:27], v6, s[44:47], s29 offen sc1
    v_pk_fma_f32 v[152:153], v[152:153], v[128:129], v[132:133]
    v_pk_fma_f32 v[154:155], v[154:155], v[130:131], v[134:135]
    v_pk_fma_f32 v[156:157], v[156:157], v[136:137], v[140:141]
    v_pk_fma_f32 v[158:159], v[158:159], v[138:139], v[142:143]
    v_cvt_pk_bf16_f32 v28, v152, v153
    v_cvt_pk_bf16_f32 v29, v154, v155
    v_cvt_pk_bf16_f32 v30, v156, v157
    v_cvt_pk_bf16_f32 v31, v158, v159
    buffer_store_dwordx4 v[28:31], v7, s[44:47], s29 offen sc1
    v_pk_fma_f32 v[160:161], v[160:161], v[128:129], v[132:133]
    v_pk_fma_f32 v[162:163], v[162:163], v[130:131], v[134:135]
    v_pk_fma_f32 v[164:165], v[164:165], v[136:137], v[140:141]
    v_pk_fma_f32 v[166:167], v[166:167], v[138:139], v[142:143]
    v_cvt_pk_bf16_f32 v32, v160, v161
    v_cvt_pk_bf16_f32 v33, v162, v163
    v_cvt_pk_bf16_f32 v34, v164, v165
    v_cvt_pk_bf16_f32 v35, v166, v167
    buffer_store_dwordx4 v[32:35], v8, s[44:47], s29 offen sc1
    v_lshlrev_b32 v144, 16, v192
    v_and_b32 v145, s97, v192
    v_lshlrev_b32 v146, 16, v193
    v_and_b32 v147, s97, v193
    v_lshlrev_b32 v148, 16, v194
    v_and_b32 v149, s97, v194
    v_lshlrev_b32 v150, 16, v195
    v_and_b32 v151, s97, v195
    v_pk_mul_f32 v[184:185], v[144:145], v[144:145]
    v_pk_mul_f32 v[186:187], v[146:147], v[146:147]
    v_pk_mul_f32 v[188:189], v[148:149], v[148:149]
    v_pk_mul_f32 v[190:191], v[150:151], v[150:151]
    v_pk_fma_f32 v[184:185], v[184:185], s[60:61], v[0:1] op_sel_hi:[1,0,0]
    v_pk_fma_f32 v[186:187], v[186:187], s[60:61], v[0:1] op_sel_hi:[1,0,0]
    v_pk_fma_f32 v[188:189], v[188:189], s[60:61], v[0:1] op_sel_hi:[1,0,0]
    v_pk_fma_f32 v[190:191], v[190:191], s[60:61], v[0:1] op_sel_hi:[1,0,0]
    v_pk_mul_f32 v[184:185], v[184:185], v[144:145]
    v_pk_mul_f32 v[186:187], v[186:187], v[146:147]
    v_pk_mul_f32 v[188:189], v[188:189], v[148:149]
    v_pk_mul_f32 v[190:191], v[190:191], v[150:151]
    v_exp_f32 v184, v184
    v_exp_f32 v185, v185
    v_exp_f32 v186, v186
    v_exp_f32 v187, v187
    v_exp_f32 v188, v188
    v_exp_f32 v189, v189
    v_exp_f32 v190, v190
    v_exp_f32 v191, v191
    v_pk_add_f32 v[184:185], v[184:185], 1.0 op_sel_hi:[1,0]
    v_pk_add_f32 v[186:187], v[186:187], 1.0 op_sel_hi:[1,0]
    v_pk_add_f32 v[188:189], v[188:189], 1.0 op_sel_hi:[1,0]
    v_pk_add_f32 v[190:191], v[190:191], 1.0 op_sel_hi:[1,0]
    v_rcp_f32 v184, v184
    v_rcp_f32 v185, v185
    v_rcp_f32 v186, v186
    v_rcp_f32 v187, v187
    v_rcp_f32 v188, v188
    v_rcp_f32 v189, v189
    v_rcp_f32 v190, v190
    v_rcp_f32 v191, v191
    v_pk_mul_f32 v[144:145], v[144:145], v[184:185]
    v_pk_mul_f32 v[146:147], v[146:147], v[186:187]
    v_pk_mul_f32 v[148:149], v[148:149], v[188:189]
    v_pk_mul_f32 v[150:151], v[150:151], v[190:191]
    v_cvt_pk_bf16_f32 v64, v144, v145
    v_cvt_pk_bf16_f32 v65, v146, v147
    v_cvt_pk_bf16_f32 v66, v148, v149
    v_cvt_pk_bf16_f32 v67, v150, v151
    v_lshlrev_b32 v144, 16, v64
    v_and_b32 v145, s97, v64
    v_lshlrev_b32 v146, 16, v65
    v_and_b32 v147, s97, v65
    v_lshlrev_b32 v148, 16, v66
    v_and_b32 v149, s97, v66
    v_lshlrev_b32 v150, 16, v67
    v_and_b32 v151, s97, v67
    v_lshlrev_b32 v152, 16, v196
    v_and_b32 v153, s97, v196
    v_lshlrev_b32 v154, 16, v197
    v_and_b32 v155, s97, v197
    v_lshlrev_b32 v156, 16, v198
    v_and_b32 v157, s97, v198
    v_lshlrev_b32 v158, 16, v199
    v_and_b32 v159, s97, v199
    v_pk_mul_f32 v[184:185], v[152:153], v[152:153]
    v_pk_mul_f32 v[186:187], v[154:155], v[154:155]
    v_pk_mul_f32 v[188:189], v[156:157], v[156:157]
    v_pk_mul_f32 v[190:191], v[158:159], v[158:159]
    v_pk_fma_f32 v[184:185], v[184:185], s[60:61], v[0:1] op_sel_hi:[1,0,0]
    v_pk_fma_f32 v[186:187], v[186:187], s[60:61], v[0:1] op_sel_hi:[1,0,0]
    v_pk_fma_f32 v[188:189], v[188:189], s[60:61], v[0:1] op_sel_hi:[1,0,0]
    v_pk_fma_f32 v[190:191], v[190:191], s[60:61], v[0:1] op_sel_hi:[1,0,0]
    v_pk_mul_f32 v[184:185], v[184:185], v[152:153]
    v_pk_mul_f32 v[186:187], v[186:187], v[154:155]
    v_pk_mul_f32 v[188:189], v[188:189], v[156:157]
    v_pk_mul_f32 v[190:191], v[190:191], v[158:159]
    v_exp_f32 v184, v184
    v_exp_f32 v185, v185
    v_exp_f32 v186, v186
    v_exp_f32 v187, v187
    v_exp_f32 v188, v188
    v_exp_f32 v189, v189
    v_exp_f32 v190, v190
    v_exp_f32 v191, v191
    v_pk_add_f32 v[184:185], v[184:185], 1.0 op_sel_hi:[1,0]
    v_pk_add_f32 v[186:187], v[186:187], 1.0 op_sel_hi:[1,0]
    v_pk_add_f32 v[188:189], v[188:189], 1.0 op_sel_hi:[1,0]
    v_pk_add_f32 v[190:191], v[190:191], 1.0 op_sel_hi:[1,0]
    v_rcp_f32 v184, v184
    v_rcp_f32 v185, v185
    v_rcp_f32 v186, v186
    v_rcp_f32 v187, v187
    v_rcp_f32 v188, v188
    v_rcp_f32 v189, v189
    v_rcp_f32 v190, v190
    v_rcp_f32 v191, v191
    v_pk_mul_f32 v[152:153], v[152:153], v[184:185]
    v_pk_mul_f32 v[154:155], v[154:155], v[186:187]
    v_pk_mul_f32 v[156:157], v[156:157], v[188:189]
    v_pk_mul_f32 v[158:159], v[158:159], v[190:191]
    v_cvt_pk_bf16_f32 v64, v152, v153
    v_cvt_pk_bf16_f32 v65, v154, v155
    v_cvt_pk_bf16_f32 v66, v156, v157
    v_cvt_pk_bf16_f32 v67, v158, v159
    v_lshlrev_b32 v152, 16, v64
    v_and_b32 v153, s97, v64
    v_lshlrev_b32 v154, 16, v65
    v_and_b32 v155, s97, v65
    v_lshlrev_b32 v156, 16, v66
    v_and_b32 v157, s97, v66
    v_lshlrev_b32 v158, 16, v67
    v_and_b32 v159, s97, v67
    s_waitcnt vmcnt(0)
    s_barrier
    v_lshlrev_b32 v160, 16, v200
    v_and_b32 v161, s97, v200
    v_lshlrev_b32 v162, 16, v201
    v_and_b32 v163, s97, v201
    v_lshlrev_b32 v164, 16, v202
    v_and_b32 v165, s97, v202
    v_lshlrev_b32 v166, 16, v203
    v_and_b32 v167, s97, v203
    v_pk_mul_f32 v[184:185], v[160:161], v[160:161]
    v_pk_mul_f32 v[186:187], v[162:163], v[162:163]
    v_pk_mul_f32 v[188:189], v[164:165], v[164:165]
    v_pk_mul_f32 v[190:191], v[166:167], v[166:167]
    v_pk_fma_f32 v[184:185], v[184:185], s[60:61], v[0:1] op_sel_hi:[1,0,0]
    v_pk_fma_f32 v[186:187], v[186:187], s[60:61], v[0:1] op_sel_hi:[1,0,0]
    v_pk_fma_f32 v[188:189], v[188:189], s[60:61], v[0:1] op_sel_hi:[1,0,0]
    v_pk_fma_f32 v[190:191], v[190:191], s[60:61], v[0:1] op_sel_hi:[1,0,0]
    v_pk_mul_f32 v[184:185], v[184:185], v[160:161]
    v_pk_mul_f32 v[186:187], v[186:187], v[162:163]
    v_pk_mul_f32 v[188:189], v[188:189], v[164:165]
    v_pk_mul_f32 v[190:191], v[190:191], v[166:167]
    v_exp_f32 v184, v184
    v_exp_f32 v185, v185
    v_exp_f32 v186, v186
    v_exp_f32 v187, v187
    v_exp_f32 v188, v188
    v_exp_f32 v189, v189
    v_exp_f32 v190, v190
    v_exp_f32 v191, v191
    v_pk_add_f32 v[184:185], v[184:185], 1.0 op_sel_hi:[1,0]
    v_pk_add_f32 v[186:187], v[186:187], 1.0 op_sel_hi:[1,0]
    v_pk_add_f32 v[188:189], v[188:189], 1.0 op_sel_hi:[1,0]
    v_pk_add_f32 v[190:191], v[190:191], 1.0 op_sel_hi:[1,0]
    v_rcp_f32 v184, v184
    v_rcp_f32 v185, v185
    v_rcp_f32 v186, v186
    v_rcp_f32 v187, v187
    v_rcp_f32 v188, v188
    v_rcp_f32 v189, v189
    v_rcp_f32 v190, v190
    v_rcp_f32 v191, v191
    v_pk_mul_f32 v[160:161], v[160:161], v[184:185]
    v_pk_mul_f32 v[162:163], v[162:163], v[186:187]
    v_pk_mul_f32 v[164:165], v[164:165], v[188:189]
    v_pk_mul_f32 v[166:167], v[166:167], v[190:191]
    v_cvt_pk_bf16_f32 v64, v160, v161
    v_cvt_pk_bf16_f32 v65, v162, v163
    v_cvt_pk_bf16_f32 v66, v164, v165
    v_cvt_pk_bf16_f32 v67, v166, v167
    v_lshlrev_b32 v160, 16, v64
    v_and_b32 v161, s97, v64
    v_lshlrev_b32 v162, 16, v65
    v_and_b32 v163, s97, v65
    v_lshlrev_b32 v164, 16, v66
    v_and_b32 v165, s97, v66
    v_lshlrev_b32 v166, 16, v67
    v_and_b32 v167, s97, v67
    v_lshlrev_b32 v168, 16, v228
    v_and_b32 v169, s97, v228
    v_lshlrev_b32 v170, 16, v229
    v_and_b32 v171, s97, v229
    v_lshlrev_b32 v172, 16, v230
    v_and_b32 v173, s97, v230
    v_lshlrev_b32 v174, 16, v231
    v_and_b32 v175, s97, v231
    v_lshrrev_b32 v13, 1, v3
    v_xor_b32 v13, v13, v9
    v_lshlrev_b32 v14, 7, v3
    s_lshl_b32 s24, s7, 12
    s_add_u32 s24, s24, 4096
    v_add_u32_e64 v14, s24, v14
    v_lshl_add_u32 v15, v13, 4, v14
    v_xor_b32_e64 v13, 4, v13
    v_lshl_add_u32 v16, v13, 4, v14
    s_mul_i32 s24, s8, 3072
    s_add_u32 s24, s24, 12288
    v_add_u32 v17, s24, v4
    v_mov_b32 v18, v15
    v_mov_b32 v19, v16
    v_mov_b32 v20, v17
    v_mov_b32 v104, 0
    v_mov_b32 v105, 0
    v_mov_b32 v106, 0
    v_mov_b32 v107, 0
    v_mov_b32 v108, 0
    v_mov_b32 v109, 0
    v_mov_b32 v110, 0
    v_mov_b32 v111, 0
    v_mov_b32 v112, 0
    v_mov_b32 v113, 0
    v_mov_b32 v114, 0
    v_mov_b32 v115, 0
    v_mov_b32 v116, 0
    v_mov_b32 v117, 0
    v_mov_b32 v118, 0
    v_mov_b32 v119, 0
    v_mov_b32 v120, 0
    v_mov_b32 v121, 0
    v_mov_b32 v122, 0
    v_mov_b32 v123, 0
    v_mov_b32 v124, 0
    v_mov_b32 v125, 0
    v_mov_b32 v126, 0
    v_mov_b32 v127, 0
    s_barrier
    s_barrier
    ds_read_b128 v[24:27], v18 offset:0
    ds_read_b128 v[28:31], v18 offset:2048
    ds_read_b128 v[32:35], v20 offset:0
    ds_read_b128 v[36:39], v20 offset:1024
    ds_read_b128 v[40:43], v20 offset:2048
    ds_read_b128 v[44:47], v19 offset:0
    ds_read_b128 v[48:51], v19 offset:2048
    ds_read_b128 v[52:55], v20 offset:6144
    ds_read_b128 v[56:59], v20 offset:7168
    ds_read_b128 v[60:63], v20 offset:8192
    s_mov_b32 s28, 0
    s_mov_b32 s71, 20480
    v_add_u32 v18, s71, v15
    v_add_u32 v19, s71, v16
    v_add_u32 v20, s71, v17
    .p2align 6
kcd_dloop:
    s_waitcnt lgkmcnt(5)
    s_barrier
    v_mfma_f32_16x16x32_bf16 v[104:107], v[24:27], v[32:35], v[104:107]
    ds_read_b128 v[64:67], v18 offset:0
    v_mfma_f32_16x16x32_bf16 v[116:119], v[28:31], v[32:35], v[116:119]
    ds_read_b128 v[68:71], v18 offset:2048
    v_mfma_f32_16x16x32_bf16 v[108:111], v[24:27], v[36:39], v[108:111]
    ds_read_b128 v[72:75], v20 offset:0
    v_mfma_f32_16x16x32_bf16 v[120:123], v[28:31], v[36:39], v[120:123]
    ds_read_b128 v[76:79], v20 offset:1024
    v_mfma_f32_16x16x32_bf16 v[112:115], v[24:27], v[40:43], v[112:115]
    ds_read_b128 v[80:83], v20 offset:2048
    v_mfma_f32_16x16x32_bf16 v[124:127], v[28:31], v[40:43], v[124:127]
    s_waitcnt lgkmcnt(5)
    s_nop 0
    v_mfma_f32_16x16x32_bf16 v[104:107], v[44:47], v[52:55], v[104:107]
    ds_read_b128 v[84:87], v19 offset:0
    s_add_u32 s71, s71, 20480
    v_mfma_f32_16x16x32_bf16 v[116:119], v[48:51], v[52:55], v[116:119]
    ds_read_b128 v[88:91], v19 offset:2048
    s_cmp_eq_u32 s71, 143360
    v_mfma_f32_16x16x32_bf16 v[108:111], v[44:47], v[56:59], v[108:111]
    ds_read_b128 v[92:95], v20 offset:6144
    s_cselect_b32 s71, 0, s71
    v_mfma_f32_16x16x32_bf16 v[120:123], v[48:51], v[56:59], v[120:123]
    ds_read_b128 v[96:99], v20 offset:7168
    v_add_u32 v18, s71, v15
    v_mfma_f32_16x16x32_bf16 v[112:115], v[44:47], v[60:63], v[112:115]
    ds_read_b128 v[100:103], v20 offset:8192
    v_add_u32_e64 v19, s71, v16
    v_mfma_f32_16x16x32_bf16 v[124:127], v[48:51], v[60:63], v[124:127]
    v_add_u32 v20, s71, v17
    s_waitcnt lgkmcnt(5)
    s_barrier
    s_nop 0
    v_mfma_f32_16x16x32_bf16 v[104:107], v[64:67], v[72:75], v[104:107]
    ds_read_b128 v[24:27], v18 offset:0
    v_mfma_f32_16x16x32_bf16 v[116:119], v[68:71], v[72:75], v[116:119]
    ds_read_b128 v[28:31], v18 offset:2048
    v_mfma_f32_16x16x32_bf16 v[108:111], v[64:67], v[76:79], v[108:111]
    ds_read_b128 v[32:35], v20 offset:0
    v_mfma_f32_16x16x32_bf16 v[120:123], v[68:71], v[76:79], v[120:123]
    ds_read_b128 v[36:39], v20 offset:1024
    v_mfma_f32_16x16x32_bf16 v[112:115], v[64:67], v[80:83], v[112:115]
    ds_read_b128 v[40:43], v20 offset:2048
    v_mfma_f32_16x16x32_bf16 v[124:127], v[68:71], v[80:83], v[124:127]
    s_waitcnt lgkmcnt(5)
    s_nop 0
    v_mfma_f32_16x16x32_bf16 v[104:107], v[84:87], v[92:95], v[104:107]
    ds_read_b128 v[44:47], v19 offset:0
    s_add_u32 s71, s71, 20480
    v_mfma_f32_16x16x32_bf16 v[116:119], v[88:91], v[92:95], v[116:119]
    ds_read_b128 v[48:51], v19 offset:2048
    s_cmp_eq_u32 s71, 143360
    v_mfma_f32_16x16x32_bf16 v[108:111], v[84:87], v[96:99], v[108:111]
    ds_read_b128 v[52:55], v20 offset:6144
    s_cselect_b32 s71, 0, s71
    v_mfma_f32_16x16x32_bf16 v[120:123], v[88:91], v[96:99], v[120:123]
    ds_read_b128 v[56:59], v20 offset:7168
    v_add_u32 v18, s71, v15
    v_mfma_f32_16x16x32_bf16 v[112:115], v[84:87], v[100:103], v[112:115]
    ds_read_b128 v[60:63], v20 offset:8192
    v_add_u32_e64 v19, s71, v16
    v_mfma_f32_16x16x32_bf16 v[124:127], v[88:91], v[100:103], v[124:127]
    v_add_u32 v20, s71, v17
    s_add_u32 s28, s28, 2
    s_cmp_lt_u32 s28, 32
    s_cbranch_scc1 kcd_dloop
    s_waitcnt lgkmcnt(0)
    s_nop 0
    v_cvt_pk_bf16_f32 v24, v104, v105
    v_cvt_pk_bf16_f32 v25, v106, v107
    v_cvt_pk_bf16_f32 v26, v116, v117
    v_cvt_pk_bf16_f32 v27, v118, v119
    v_cvt_pk_bf16_f32 v28, v108, v109
    v_cvt_pk_bf16_f32 v29, v110, v111
    v_cvt_pk_bf16_f32 v30, v120, v121
    v_cvt_pk_bf16_f32 v31, v122, v123
    v_cvt_pk_bf16_f32 v32, v112, v113
    v_cvt_pk_bf16_f32 v33, v114, v115
    v_cvt_pk_bf16_f32 v34, v124, v125
    v_cvt_pk_bf16_f32 v35, v126, v127
    v_lshlrev_b32 v104, 16, v24
    v_and_b32 v105, s97, v24
    v_lshlrev_b32 v106, 16, v25
    v_and_b32 v107, s97, v25
    v_lshlrev_b32 v116, 16, v26
    v_and_b32 v117, s97, v26
    v_lshlrev_b32 v118, 16, v27
    v_and_b32 v119, s97, v27
    v_lshlrev_b32 v108, 16, v28
    v_and_b32 v109, s97, v28
    v_lshlrev_b32 v110, 16, v29
    v_and_b32 v111, s97, v29
    v_lshlrev_b32 v120, 16, v30
    v_and_b32 v121, s97, v30
    v_lshlrev_b32 v122, 16, v31
    v_and_b32 v123, s97, v31
    v_lshlrev_b32 v112, 16, v32
    v_and_b32 v113, s97, v32
    v_lshlrev_b32 v114, 16, v33
    v_and_b32 v115, s97, v33
    v_lshlrev_b32 v124, 16, v34
    v_and_b32 v125, s97, v34
    v_lshlrev_b32 v126, 16, v35
    v_and_b32 v127, s97, v35
    v_pk_add_f32 v[104:105], v[104:105], v[168:169]
    v_pk_add_f32 v[106:107], v[106:107], v[170:171]
    v_pk_add_f32 v[116:117], v[116:117], v[172:173]
    v_pk_add_f32 v[118:119], v[118:119], v[174:175]
    v_pk_add_f32 v[108:109], v[108:109], v[168:169]
    v_pk_add_f32 v[110:111], v[110:111], v[170:171]
    v_pk_add_f32 v[120:121], v[120:121], v[172:173]
    v_pk_add_f32 v[122:123], v[122:123], v[174:175]
    v_pk_add_f32 v[112:113], v[112:113], v[168:169]
    v_pk_add_f32 v[114:115], v[114:115], v[170:171]
    v_pk_add_f32 v[124:125], v[124:125], v[172:173]
    v_pk_add_f32 v[126:127], v[126:127], v[174:175]
    v_cvt_pk_bf16_f32 v24, v104, v105
    v_cvt_pk_bf16_f32 v25, v106, v107
    v_cvt_pk_bf16_f32 v26, v116, v117
    v_cvt_pk_bf16_f32 v27, v118, v119
    v_cvt_pk_bf16_f32 v28, v108, v109
    v_cvt_pk_bf16_f32 v29, v110, v111
    v_cvt_pk_bf16_f32 v30, v120, v121
    v_cvt_pk_bf16_f32 v31, v122, v123
    v_cvt_pk_bf16_f32 v32, v112, v113
    v_cvt_pk_bf16_f32 v33, v114, v115
    v_cvt_pk_bf16_f32 v34, v124, v125
    v_cvt_pk_bf16_f32 v35, v126, v127
    v_lshlrev_b32 v104, 16, v24
    v_and_b32 v105, s97, v24
    v_lshlrev_b32 v106, 16, v25
    v_and_b32 v107, s97, v25
    v_lshlrev_b32 v116, 16, v26
    v_and_b32 v117, s97, v26
    v_lshlrev_b32 v118, 16, v27
    v_and_b32 v119, s97, v27
    v_lshlrev_b32 v108, 16, v28
    v_and_b32 v109, s97, v28
    v_lshlrev_b32 v110, 16, v29
    v_and_b32 v111, s97, v29
    v_lshlrev_b32 v120, 16, v30
    v_and_b32 v121, s97, v30
    v_lshlrev_b32 v122, 16, v31
    v_and_b32 v123, s97, v31
    v_lshlrev_b32 v112, 16, v32
    v_and_b32 v113, s97, v32
    v_lshlrev_b32 v114, 16, v33
    v_and_b32 v115, s97, v33
    v_lshlrev_b32 v124, 16, v34
    v_and_b32 v125, s97, v34
    v_lshlrev_b32 v126, 16, v35
    v_and_b32 v127, s97, v35
    v_pk_mul_f32 v[104:105], v[104:105], v[144:145]
    v_pk_mul_f32 v[106:107], v[106:107], v[146:147]
    v_pk_mul_f32 v[116:117], v[116:117], v[148:149]
    v_pk_mul_f32 v[118:119], v[118:119], v[150:151]
    v_pk_mul_f32 v[108:109], v[108:109], v[152:153]
    v_pk_mul_f32 v[110:111], v[110:111], v[154:155]
    v_pk_mul_f32 v[120:121], v[120:121], v[156:157]
    v_pk_mul_f32 v[122:123], v[122:123], v[158:159]
    v_pk_mul_f32 v[112:113], v[112:113], v[160:161]
    v_pk_mul_f32 v[114:115], v[114:115], v[162:163]
    v_pk_mul_f32 v[124:125], v[124:125], v[164:165]
    v_pk_mul_f32 v[126:127], v[126:127], v[166:167]
    v_cvt_pk_bf16_f32 v44, v104, v105
    v_cvt_pk_bf16_f32 v45, v106, v107
    buffer_store_dwordx2 v[44:45], v21, s[48:51], 0 offen offset:0 sc1
    v_cvt_pk_bf16_f32 v46, v116, v117
    v_cvt_pk_bf16_f32 v47, v118, v119
    buffer_store_dwordx2 v[46:47], v21, s[56:59], 0 offen offset:0 sc1
    v_cvt_pk_bf16_f32 v48, v108, v109
    v_cvt_pk_bf16_f32 v49, v110, v111
    buffer_store_dwordx2 v[48:49], v21, s[48:51], 0 offen offset:512 sc1
    v_cvt_pk_bf16_f32 v50, v120, v121
    v_cvt_pk_bf16_f32 v51, v122, v123
    buffer_store_dwordx2 v[50:51], v21, s[56:59], 0 offen offset:512 sc1
    v_cvt_pk_bf16_f32 v52, v112, v113
    v_cvt_pk_bf16_f32 v53, v114, v115
    buffer_store_dwordx2 v[52:53], v21, s[48:51], 0 offen offset:1024 sc1
    v_cvt_pk_bf16_f32 v54, v124, v125
    v_cvt_pk_bf16_f32 v55, v126, v127
    buffer_store_dwordx2 v[54:55], v21, s[56:59], 0 offen offset:1024 sc1
    s_waitcnt vmcnt(0)
    s_barrier
    v_add_u32 v5, 4096, v4
    v_add_u32 v6, 65536, v4
    v_add_u32 v7, 126976, v4
    s_cmp_eq_u32 s8, 1
    s_cbranch_scc1 kcd_w1
    ds_read_b128 v[56:59], v6 offset:20480
    ds_read_b128 v[60:63], v6 offset:21504
    ds_read_b128 v[64:67], v6 offset:22528
    ds_read_b128 v[68:71], v6 offset:23552
    ds_read_b128 v[72:75], v6 offset:24576
    ds_read_b128 v[76:79], v6 offset:25600
    ds_read_b128 v[80:83], v6 offset:26624
    ds_read_b128 v[84:87], v6 offset:27648
    ds_read_b128 v[88:91], v6 offset:28672
    ds_read_b128 v[92:95], v6 offset:29696
    ds_read_b128 v[96:99], v6 offset:30720
    ds_read_b128 v[100:103], v6 offset:31744
    ds_read_b128 v[104:107], v6 offset:32768
    ds_read_b128 v[108:111], v6 offset:33792
    ds_read_b128 v[112:115], v6 offset:34816
    ds_read_b128 v[116:119], v6 offset:35840
    ds_read_b128 v[120:123], v6 offset:36864
    ds_read_b128 v[124:127], v6 offset:37888
    ds_read_b128 v[128:131], v6 offset:38912
    ds_read_b128 v[132:135], v6 offset:39936
    ds_read_b128 v[136:139], v6 offset:40960
    ds_read_b128 v[140:143], v6 offset:41984
    ds_read_b128 v[144:147], v6 offset:43008
    ds_read_b128 v[148:151], v6 offset:44032
    ds_read_b128 v[152:155], v6 offset:45056
    ds_read_b128 v[156:159], v6 offset:46080
    ds_read_b128 v[160:163], v6 offset:47104
    ds_read_b128 v[164:167], v6 offset:48128
    ds_read_b128 v[168:171], v6 offset:49152
    ds_read_b128 v[172:175], v6 offset:50176
    ds_read_b128 v[176:179], v6 offset:51200
    ds_read_b128 v[180:183], v6 offset:52224
    ds_read_b128 v[184:187], v6 offset:53248
    ds_read_b128 v[188:191], v6 offset:54272
    ds_read_b128 v[192:195], v6 offset:55296
    ds_read_b128 v[196:199], v6 offset:56320
    ds_read_b128 v[200:203], v6 offset:57344
    ds_read_b128 v[204:207], v6 offset:58368
    ds_read_b128 v[208:211], v6 offset:59392
    ds_read_b128 v[212:215], v6 offset:60416
    ds_read_b128 v[216:219], v7 offset:0
    ds_read_b128 v[220:223], v7 offset:1024
    ds_read_b128 v[224:227], v7 offset:2048
    ds_read_b128 v[228:231], v7 offset:3072
    s_branch kcd_w2
kcd_w1:
    ds_read_b128 v[56:59], v7 offset:4096
    ds_read_b128 v[60:63], v7 offset:5120
    ds_read_b128 v[64:67], v7 offset:6144
    ds_read_b128 v[68:71], v7 offset:7168
    ds_read_b128 v[72:75], v7 offset:8192
    ds_read_b128 v[76:79], v7 offset:9216
    ds_read_b128 v[80:83], v7 offset:10240
    ds_read_b128 v[84:87], v7 offset:11264
    ds_read_b128 v[88:91], v7 offset:12288
    ds_read_b128 v[92:95], v7 offset:13312
    ds_read_b128 v[96:99], v7 offset:14336
    ds_read_b128 v[100:103], v7 offset:15360
    ds_read_b128 v[104:107], v7 offset:16384
    ds_read_b128 v[108:111], v7 offset:17408
    ds_read_b128 v[112:115], v7 offset:18432
    ds_read_b128 v[116:119], v7 offset:19456
    ds_read_b128 v[120:123], v5 offset:0
    ds_read_b128 v[124:127], v5 offset:1024
    ds_read_b128 v[128:131], v5 offset:2048
    ds_read_b128 v[132:135], v5 offset:3072
    ds_read_b128 v[136:139], v5 offset:4096
    ds_read_b128 v[140:143], v5 offset:5120
    ds_read_b128 v[144:147], v5 offset:6144
    ds_read_b128 v[148:151], v5 offset:7168
    ds_read_b128 v[152:155], v5 offset:8192
    ds_read_b128 v[156:159], v5 offset:9216
    ds_read_b128 v[160:163], v5 offset:10240
    ds_read_b128 v[164:167], v5 offset:11264
    ds_read_b128 v[168:171], v5 offset:12288
    ds_read_b128 v[172:175], v5 offset:13312
    ds_read_b128 v[176:179], v5 offset:14336
    ds_read_b128 v[180:183], v5 offset:15360
    ds_read_b128 v[184:187], v5 offset:16384
    ds_read_b128 v[188:191], v5 offset:17408
    ds_read_b128 v[192:195], v5 offset:18432
    ds_read_b128 v[196:199], v5 offset:19456
    ds_read_b128 v[200:203], v5 offset:20480
    ds_read_b128 v[204:207], v5 offset:21504
    ds_read_b128 v[208:211], v5 offset:22528
    ds_read_b128 v[212:215], v5 offset:23552
    ds_read_b128 v[216:219], v5 offset:24576
    ds_read_b128 v[220:223], v5 offset:25600
    ds_read_b128 v[224:227], v5 offset:26624
    ds_read_b128 v[228:231], v5 offset:27648
kcd_w2:
    v_bfe_u32 v18, v1, 2, 2
    v_and_b32 v19, 3, v1
    v_and_b32_e64 v20, 1, v9
    v_lshl_add_u32 v18, v20, 3, v18
    v_lshrrev_b32_e64 v20, 1, v19
    v_lshl_add_u32 v18, v20, 2, v18
    v_lshl_add_u32 v18, v19, 4, v18
    v_lshlrev_b32 v18, 3, v18
    v_lshrrev_b32 v20, 1, v9
    v_lshl_add_u32 v18, v20, 9, v18
    s_mul_i32 s24, s7, 45056
    s_add_u32 s24, s24, 4096
    v_add_u32 v18, s24, v18
    v_xor_b32 v19, 32, v18
    s_waitcnt lgkmcnt(0)
    s_barrier
    s_barrier
    s_nop 0
    ds_read_b64_tr_b16 v[24:25], v18 offset:0
    ds_read_b64_tr_b16 v[26:27], v19 offset:0
    ds_read_b64_tr_b16 v[28:29], v18 offset:22528
    ds_read_b64_tr_b16 v[30:31], v19 offset:22528
    ds_read_b64_tr_b16 v[32:33], v18 offset:1024
    ds_read_b64_tr_b16 v[34:35], v19 offset:1024
    ds_read_b64_tr_b16 v[36:37], v18 offset:23552
    ds_read_b64_tr_b16 v[38:39], v19 offset:23552
    s_waitcnt lgkmcnt(4)
    s_nop 0
    v_mfma_f32_16x16x32_bf16 v[40:43], v[56:59], v[24:27], 0
    ds_read_b64_tr_b16 v[248:249], v18 offset:2048
    v_mfma_f32_16x16x32_bf16 v[48:51], v[56:59], v[28:31], 0
    ds_read_b64_tr_b16 v[250:251], v19 offset:2048
    v_mfma_f32_16x16x32_bf16 v[44:47], v[144:147], v[24:27], 0
    ds_read_b64_tr_b16 v[252:253], v18 offset:24576
    v_mfma_f32_16x16x32_bf16 v[52:55], v[144:147], v[28:31], 0
    ds_read_b64_tr_b16 v[254:255], v19 offset:24576
    s_waitcnt lgkmcnt(4)
    s_nop 0
    v_mfma_f32_16x16x32_bf16 v[40:43], v[60:63], v[32:35], v[40:43]
    ds_read_b64_tr_b16 v[24:25], v18 offset:3072
    v_mfma_f32_16x16x32_bf16 v[48:51], v[60:63], v[36:39], v[48:51]
    ds_read_b64_tr_b16 v[26:27], v19 offset:3072
    v_mfma_f32_16x16x32_bf16 v[44:47], v[148:151], v[32:35], v[44:47]
    ds_read_b64_tr_b16 v[28:29], v18 offset:25600
    v_mfma_f32_16x16x32_bf16 v[52:55], v[148:151], v[36:39], v[52:55]
    ds_read_b64_tr_b16 v[30:31], v19 offset:25600
    s_waitcnt lgkmcnt(4)
    v_mfma_f32_16x16x32_bf16 v[40:43], v[64:67], v[248:251], v[40:43]
    v_mfma_f32_16x16x32_bf16 v[48:51], v[64:67], v[252:255], v[48:51]
    v_mfma_f32_16x16x32_bf16 v[44:47], v[152:155], v[248:251], v[44:47]
    v_mfma_f32_16x16x32_bf16 v[52:55], v[152:155], v[252:255], v[52:55]
    s_waitcnt lgkmcnt(0)
    v_mfma_f32_16x16x32_bf16 v[40:43], v[68:71], v[24:27], v[40:43]
    v_mfma_f32_16x16x32_bf16 v[48:51], v[68:71], v[28:31], v[48:51]
    v_mfma_f32_16x16x32_bf16 v[44:47], v[156:159], v[24:27], v[44:47]
    v_mfma_f32_16x16x32_bf16 v[52:55], v[156:159], v[28:31], v[52:55]
    s_barrier
    s_nop 0
    ds_read_b64_tr_b16 v[32:33], v18 offset:4096
    ds_read_b64_tr_b16 v[34:35], v19 offset:4096
    ds_read_b64_tr_b16 v[36:37], v18 offset:26624
    ds_read_b64_tr_b16 v[38:39], v19 offset:26624
    ds_read_b64_tr_b16 v[248:249], v18 offset:5120
    ds_read_b64_tr_b16 v[250:251], v19 offset:5120
    ds_read_b64_tr_b16 v[252:253], v18 offset:27648
    ds_read_b64_tr_b16 v[254:255], v19 offset:27648
    s_waitcnt lgkmcnt(4)
    s_nop 0
    v_mfma_f32_16x16x32_bf16 v[40:43], v[72:75], v[32:35], v[40:43]
    ds_read_b64_tr_b16 v[24:25], v18 offset:6144
    v_mfma_f32_16x16x32_bf16 v[48:51], v[72:75], v[36:39], v[48:51]
    ds_read_b64_tr_b16 v[26:27], v19 offset:6144
    v_mfma_f32_16x16x32_bf16 v[44:47], v[160:163], v[32:35], v[44:47]
    ds_read_b64_tr_b16 v[28:29], v18 offset:28672
    v_mfma_f32_16x16x32_bf16 v[52:55], v[160:163], v[36:39], v[52:55]
    ds_read_b64_tr_b16 v[30:31], v19 offset:28672
    s_waitcnt lgkmcnt(4)
    s_nop 0
    v_mfma_f32_16x16x32_bf16 v[40:43], v[76:79], v[248:251], v[40:43]
    ds_read_b64_tr_b16 v[32:33], v18 offset:7168
    v_mfma_f32_16x16x32_bf16 v[48:51], v[76:79], v[252:255], v[48:51]
    ds_read_b64_tr_b16 v[34:35], v19 offset:7168
    v_mfma_f32_16x16x32_bf16 v[44:47], v[164:167], v[248:251], v[44:47]
    ds_read_b64_tr_b16 v[36:37], v18 offset:29696
    v_mfma_f32_16x16x32_bf16 v[52:55], v[164:167], v[252:255], v[52:55]
    ds_read_b64_tr_b16 v[38:39], v19 offset:29696
    s_waitcnt lgkmcnt(4)
    v_mfma_f32_16x16x32_bf16 v[40:43], v[80:83], v[24:27], v[40:43]
    v_mfma_f32_16x16x32_bf16 v[48:51], v[80:83], v[28:31], v[48:51]
    v_mfma_f32_16x16x32_bf16 v[44:47], v[168:171], v[24:27], v[44:47]
    v_mfma_f32_16x16x32_bf16 v[52:55], v[168:171], v[28:31], v[52:55]
    s_waitcnt lgkmcnt(0)
    v_mfma_f32_16x16x32_bf16 v[40:43], v[84:87], v[32:35], v[40:43]
    v_mfma_f32_16x16x32_bf16 v[48:51], v[84:87], v[36:39], v[48:51]
    v_mfma_f32_16x16x32_bf16 v[44:47], v[172:175], v[32:35], v[44:47]
    v_mfma_f32_16x16x32_bf16 v[52:55], v[172:175], v[36:39], v[52:55]
    s_barrier
    s_nop 0
    ds_read_b64_tr_b16 v[248:249], v18 offset:8192
    ds_read_b64_tr_b16 v[250:251], v19 offset:8192
    ds_read_b64_tr_b16 v[252:253], v18 offset:30720
    ds_read_b64_tr_b16 v[254:255], v19 offset:30720
    ds_read_b64_tr_b16 v[24:25], v18 offset:9216
    ds_read_b64_tr_b16 v[26:27], v19 offset:9216
    ds_read_b64_tr_b16 v[28:29], v18 offset:31744
    ds_read_b64_tr_b16 v[30:31], v19 offset:31744
    s_waitcnt lgkmcnt(4)
    s_nop 0
    v_mfma_f32_16x16x32_bf16 v[40:43], v[88:91], v[248:251], v[40:43]
    ds_read_b64_tr_b16 v[32:33], v18 offset:10240
    v_mfma_f32_16x16x32_bf16 v[48:51], v[88:91], v[252:255], v[48:51]
    ds_read_b64_tr_b16 v[34:35], v19 offset:10240
    v_mfma_f32_16x16x32_bf16 v[44:47], v[176:179], v[248:251], v[44:47]
    ds_read_b64_tr_b16 v[36:37], v18 offset:32768
    v_mfma_f32_16x16x32_bf16 v[52:55], v[176:179], v[252:255], v[52:55]
    ds_read_b64_tr_b16 v[38:39], v19 offset:32768
    s_waitcnt lgkmcnt(4)
    s_nop 0
    v_mfma_f32_16x16x32_bf16 v[40:43], v[92:95], v[24:27], v[40:43]
    ds_read_b64_tr_b16 v[248:249], v18 offset:11264
    v_mfma_f32_16x16x32_bf16 v[48:51], v[92:95], v[28:31], v[48:51]
    ds_read_b64_tr_b16 v[250:251], v19 offset:11264
    v_mfma_f32_16x16x32_bf16 v[44:47], v[180:183], v[24:27], v[44:47]
    ds_read_b64_tr_b16 v[252:253], v18 offset:33792
    v_mfma_f32_16x16x32_bf16 v[52:55], v[180:183], v[28:31], v[52:55]
    ds_read_b64_tr_b16 v[254:255], v19 offset:33792
    s_waitcnt lgkmcnt(4)
    s_nop 0
    v_mfma_f32_16x16x32_bf16 v[40:43], v[96:99], v[32:35], v[40:43]
    ds_read_b64_tr_b16 v[24:25], v18 offset:12288
    v_mfma_f32_16x16x32_bf16 v[48:51], v[96:99], v[36:39], v[48:51]
    ds_read_b64_tr_b16 v[26:27], v19 offset:12288
    v_mfma_f32_16x16x32_bf16 v[44:47], v[184:187], v[32:35], v[44:47]
    ds_read_b64_tr_b16 v[28:29], v18 offset:34816
    v_mfma_f32_16x16x32_bf16 v[52:55], v[184:187], v[36:39], v[52:55]
    ds_read_b64_tr_b16 v[30:31], v19 offset:34816
    s_waitcnt lgkmcnt(4)
    v_mfma_f32_16x16x32_bf16 v[40:43], v[100:103], v[248:251], v[40:43]
    v_mfma_f32_16x16x32_bf16 v[48:51], v[100:103], v[252:255], v[48:51]
    v_mfma_f32_16x16x32_bf16 v[44:47], v[188:191], v[248:251], v[44:47]
    v_mfma_f32_16x16x32_bf16 v[52:55], v[188:191], v[252:255], v[52:55]
    s_waitcnt lgkmcnt(0)
    v_mfma_f32_16x16x32_bf16 v[40:43], v[104:107], v[24:27], v[40:43]
    v_mfma_f32_16x16x32_bf16 v[48:51], v[104:107], v[28:31], v[48:51]
    v_mfma_f32_16x16x32_bf16 v[44:47], v[192:195], v[24:27], v[44:47]
    v_mfma_f32_16x16x32_bf16 v[52:55], v[192:195], v[28:31], v[52:55]
    s_barrier
    s_nop 0
    ds_read_b64_tr_b16 v[32:33], v18 offset:13312
    ds_read_b64_tr_b16 v[34:35], v19 offset:13312
    ds_read_b64_tr_b16 v[36:37], v18 offset:35840
    ds_read_b64_tr_b16 v[38:39], v19 offset:35840
    ds_read_b64_tr_b16 v[248:249], v18 offset:14336
    ds_read_b64_tr_b16 v[250:251], v19 offset:14336
    ds_read_b64_tr_b16 v[252:253], v18 offset:36864
    ds_read_b64_tr_b16 v[254:255], v19 offset:36864
    s_waitcnt lgkmcnt(4)
    s_nop 0
    v_mfma_f32_16x16x32_bf16 v[40:43], v[108:111], v[32:35], v[40:43]
    ds_read_b64_tr_b16 v[24:25], v18 offset:15360
    v_mfma_f32_16x16x32_bf16 v[48:51], v[108:111], v[36:39], v[48:51]
    ds_read_b64_tr_b16 v[26:27], v19 offset:15360
    v_mfma_f32_16x16x32_bf16 v[44:47], v[196:199], v[32:35], v[44:47]
    ds_read_b64_tr_b16 v[28:29], v18 offset:37888
    v_mfma_f32_16x16x32_bf16 v[52:55], v[196:199], v[36:39], v[52:55]
    ds_read_b64_tr_b16 v[30:31], v19 offset:37888
    s_waitcnt lgkmcnt(4)
    s_nop 0
    v_mfma_f32_16x16x32_bf16 v[40:43], v[112:115], v[248:251], v[40:43]
    ds_read_b64_tr_b16 v[32:33], v18 offset:16384
    v_mfma_f32_16x16x32_bf16 v[48:51], v[112:115], v[252:255], v[48:51]
    ds_read_b64_tr_b16 v[34:35], v19 offset:16384
    v_mfma_f32_16x16x32_bf16 v[44:47], v[200:203], v[248:251], v[44:47]
    ds_read_b64_tr_b16 v[36:37], v18 offset:38912
    v_mfma_f32_16x16x32_bf16 v[52:55], v[200:203], v[252:255], v[52:55]
    ds_read_b64_tr_b16 v[38:39], v19 offset:38912
    s_waitcnt lgkmcnt(4)
    s_nop 0
    v_mfma_f32_16x16x32_bf16 v[40:43], v[116:119], v[24:27], v[40:43]
    ds_read_b64_tr_b16 v[248:249], v18 offset:17408
    v_mfma_f32_16x16x32_bf16 v[48:51], v[116:119], v[28:31], v[48:51]
    ds_read_b64_tr_b16 v[250:251], v19 offset:17408
    v_mfma_f32_16x16x32_bf16 v[44:47], v[204:207], v[24:27], v[44:47]
    ds_read_b64_tr_b16 v[252:253], v18 offset:39936
    v_mfma_f32_16x16x32_bf16 v[52:55], v[204:207], v[28:31], v[52:55]
    ds_read_b64_tr_b16 v[254:255], v19 offset:39936
    s_waitcnt lgkmcnt(4)
    v_mfma_f32_16x16x32_bf16 v[40:43], v[120:123], v[32:35], v[40:43]
    v_mfma_f32_16x16x32_bf16 v[48:51], v[120:123], v[36:39], v[48:51]
    v_mfma_f32_16x16x32_bf16 v[44:47], v[208:211], v[32:35], v[44:47]
    v_mfma_f32_16x16x32_bf16 v[52:55], v[208:211], v[36:39], v[52:55]
    s_waitcnt lgkmcnt(0)
    v_mfma_f32_16x16x32_bf16 v[40:43], v[124:127], v[248:251], v[40:43]
    v_mfma_f32_16x16x32_bf16 v[48:51], v[124:127], v[252:255], v[48:51]
    v_mfma_f32_16x16x32_bf16 v[44:47], v[212:215], v[248:251], v[44:47]
    v_mfma_f32_16x16x32_bf16 v[52:55], v[212:215], v[252:255], v[52:55]
    s_barrier
    s_nop 0
    ds_read_b64_tr_b16 v[24:25], v18 offset:18432
    ds_read_b64_tr_b16 v[26:27], v19 offset:18432
    ds_read_b64_tr_b16 v[28:29], v18 offset:40960
    ds_read_b64_tr_b16 v[30:31], v19 offset:40960
    ds_read_b64_tr_b16 v[32:33], v18 offset:19456
    ds_read_b64_tr_b16 v[34:35], v19 offset:19456
    ds_read_b64_tr_b16 v[36:37], v18 offset:41984
    ds_read_b64_tr_b16 v[38:39], v19 offset:41984
    s_waitcnt lgkmcnt(4)
    s_nop 0
    v_mfma_f32_16x16x32_bf16 v[40:43], v[128:131], v[24:27], v[40:43]
    ds_read_b64_tr_b16 v[248:249], v18 offset:20480
    v_mfma_f32_16x16x32_bf16 v[48:51], v[128:131], v[28:31], v[48:51]
    ds_read_b64_tr_b16 v[250:251], v19 offset:20480
    v_mfma_f32_16x16x32_bf16 v[44:47], v[216:219], v[24:27], v[44:47]
    ds_read_b64_tr_b16 v[252:253], v18 offset:43008
    v_mfma_f32_16x16x32_bf16 v[52:55], v[216:219], v[28:31], v[52:55]
    ds_read_b64_tr_b16 v[254:255], v19 offset:43008
    s_waitcnt lgkmcnt(4)
    s_nop 0
    v_mfma_f32_16x16x32_bf16 v[40:43], v[132:135], v[32:35], v[40:43]
    ds_read_b64_tr_b16 v[24:25], v18 offset:21504
    v_mfma_f32_16x16x32_bf16 v[48:51], v[132:135], v[36:39], v[48:51]
    ds_read_b64_tr_b16 v[26:27], v19 offset:21504
    v_mfma_f32_16x16x32_bf16 v[44:47], v[220:223], v[32:35], v[44:47]
    ds_read_b64_tr_b16 v[28:29], v18 offset:44032
    v_mfma_f32_16x16x32_bf16 v[52:55], v[220:223], v[36:39], v[52:55]
    ds_read_b64_tr_b16 v[30:31], v19 offset:44032
    s_waitcnt lgkmcnt(4)
    v_mfma_f32_16x16x32_bf16 v[40:43], v[136:139], v[248:251], v[40:43]
    v_mfma_f32_16x16x32_bf16 v[48:51], v[136:139], v[252:255], v[48:51]
    v_mfma_f32_16x16x32_bf16 v[44:47], v[224:227], v[248:251], v[44:47]
    v_mfma_f32_16x16x32_bf16 v[52:55], v[224:227], v[252:255], v[52:55]
    s_waitcnt lgkmcnt(0)
    v_mfma_f32_16x16x32_bf16 v[40:43], v[140:143], v[24:27], v[40:43]
    v_mfma_f32_16x16x32_bf16 v[48:51], v[140:143], v[28:31], v[48:51]
    v_mfma_f32_16x16x32_bf16 v[44:47], v[228:231], v[24:27], v[44:47]
    v_mfma_f32_16x16x32_bf16 v[52:55], v[228:231], v[28:31], v[52:55]
    s_nop 4
    s_nop 0
    v_cvt_pk_bf16_f32 v56, v40, v41
    v_cvt_pk_bf16_f32 v58, v42, v43
    v_cvt_pk_bf16_f32 v60, v44, v45
    v_cvt_pk_bf16_f32 v62, v46, v47
    v_cvt_pk_bf16_f32 v64, v48, v49
    v_cvt_pk_bf16_f32 v66, v50, v51
    v_cvt_pk_bf16_f32 v68, v52, v53
    v_cvt_pk_bf16_f32 v70, v54, v55
    v_lshlrev_b32 v40, 16, v56
    v_and_b32 v41, s97, v56
    v_lshlrev_b32 v42, 16, v58
    v_and_b32 v43, s97, v58
    v_lshlrev_b32 v44, 16, v60
    v_and_b32 v45, s97, v60
    v_lshlrev_b32 v46, 16, v62
    v_and_b32 v47, s97, v62
    v_lshlrev_b32 v48, 16, v64
    v_and_b32 v49, s97, v64
    v_lshlrev_b32 v50, 16, v66
    v_and_b32 v51, s97, v66
    v_lshlrev_b32 v52, 16, v68
    v_and_b32 v53, s97, v68
    v_lshlrev_b32 v54, 16, v70
    v_and_b32 v55, s97, v70
    v_pk_mul_f32 v[40:41], v[40:41], v[240:241]
    v_pk_mul_f32 v[42:43], v[42:43], v[242:243]
    v_pk_mul_f32 v[44:45], v[44:45], v[244:245]
    v_pk_mul_f32 v[46:47], v[46:47], v[246:247]
    v_pk_mul_f32 v[48:49], v[48:49], v[240:241]
    v_pk_mul_f32 v[50:51], v[50:51], v[242:243]
    v_pk_mul_f32 v[52:53], v[52:53], v[244:245]
    v_pk_mul_f32 v[54:55], v[54:55], v[246:247]
    v_cvt_pk_bf16_f32 v56, v40, v41
    v_cvt_pk_bf16_f32 v58, v42, v43
    v_cvt_pk_bf16_f32 v60, v44, v45
    v_cvt_pk_bf16_f32 v62, v46, v47
    v_cvt_pk_bf16_f32 v64, v48, v49
    v_cvt_pk_bf16_f32 v66, v50, v51
    v_cvt_pk_bf16_f32 v68, v52, v53
    v_cvt_pk_bf16_f32 v70, v54, v55
    v_lshlrev_b32 v40, 16, v56
    v_and_b32 v41, s97, v56
    v_lshlrev_b32 v42, 16, v58
    v_and_b32 v43, s97, v58
    v_lshlrev_b32 v44, 16, v60
    v_and_b32 v45, s97, v60
    v_lshlrev_b32 v46, 16, v62
    v_and_b32 v47, s97, v62
    v_lshlrev_b32 v48, 16, v64
    v_and_b32 v49, s97, v64
    v_lshlrev_b32 v50, 16, v66
    v_and_b32 v51, s97, v66
    v_lshlrev_b32 v52, 16, v68
    v_and_b32 v53, s97, v68
    v_lshlrev_b32 v54, 16, v70
    v_and_b32 v55, s97, v70
    v_lshlrev_b32 v56, 16, v232
    v_and_b32 v57, s97, v232
    v_lshlrev_b32 v58, 16, v233
    v_and_b32 v59, s97, v233
    v_lshlrev_b32 v60, 16, v234
    v_and_b32 v61, s97, v234
    v_lshlrev_b32 v62, 16, v235
    v_and_b32 v63, s97, v235
    v_lshlrev_b32 v64, 16, v236
    v_and_b32 v65, s97, v236
    v_lshlrev_b32 v66, 16, v237
    v_and_b32 v67, s97, v237
    v_lshlrev_b32 v68, 16, v238
    v_and_b32 v69, s97, v238
    v_lshlrev_b32 v70, 16, v239
    v_and_b32 v71, s97, v239
    v_pk_add_f32 v[40:41], v[40:41], v[56:57]
    v_pk_add_f32 v[42:43], v[42:43], v[58:59]
    v_pk_add_f32 v[44:45], v[44:45], v[60:61]
    v_pk_add_f32 v[46:47], v[46:47], v[62:63]
    v_pk_add_f32 v[48:49], v[48:49], v[64:65]
    v_pk_add_f32 v[50:51], v[50:51], v[66:67]
    v_pk_add_f32 v[52:53], v[52:53], v[68:69]
    v_pk_add_f32 v[54:55], v[54:55], v[70:71]
    v_cvt_pk_bf16_f32 v80, v40, v41
    v_cvt_pk_bf16_f32 v81, v42, v43
    v_cvt_pk_bf16_f32 v82, v44, v45
    v_cvt_pk_bf16_f32 v83, v46, v47
    v_cvt_pk_bf16_f32 v84, v48, v49
    v_cvt_pk_bf16_f32 v85, v50, v51
    v_cvt_pk_bf16_f32 v86, v52, v53
    v_cvt_pk_bf16_f32 v87, v54, v55
    buffer_store_dwordx2 v[80:81], v22, s[80:83], s64 offen offset:0
    buffer_store_dwordx2 v[82:83], v22, s[80:83], s64 offen offset:32
    buffer_store_dwordx2 v[84:85], v22, s[80:83], s65 offen offset:0
    buffer_store_dwordx2 v[86:87], v22, s[80:83], s65 offen offset:32
kcd_end:
    s_endpgm
kab_oob:
    s_endpgm
all_code_end:
.section .rodata,"a"
.p2align 6
.amdhsa_kernel adaLN_cond__ssm_conv_s4d__mixer_gmlp__prompt_kernel
  .amdhsa_next_free_vgpr 256
  .amdhsa_next_free_sgpr 98
  .amdhsa_accum_offset 256
  .amdhsa_group_segment_fixed_size 0
  .amdhsa_kernarg_size 136
  .amdhsa_user_sgpr_count 2
  .amdhsa_user_sgpr_kernarg_segment_ptr 1
  .amdhsa_system_sgpr_workgroup_id_x 1
  .amdhsa_float_denorm_mode_32 3
.end_amdhsa_kernel
```
